```python
import torch

def _softmax(x, axis=-1):
    return torch.softmax(x, dim=axis)
def _gelu(x):
    return torch.nn.functional.gelu(x, approximate="tanh")
def _silu(x):
    return torch.nn.functional.silu(x)
def _sigmoid(x):
    return torch.sigmoid(x)
def _layernorm(x, axis=-1, eps=1e-5):
    m = x.mean(dim=axis, keepdim=True)
    v = x.var(dim=axis, keepdim=True, unbiased=False)
    return (x - m) / torch.sqrt(v + eps)
def _scatter_add(tgt, idx, src, axis=0):
    return tgt.clone().index_add_(axis, idx, src)
def _segment_sum(src, seg, n):
    out = torch.zeros((n,) + src.shape[1:], dtype=src.dtype)
    return out.index_add_(0, seg, src)
def _pad(x, pw):
    flat = tuple(v for pair in reversed(pw) for v in pair)
    return torch.nn.functional.pad(x, flat)

kernel_name = 'sequential_preLN__gqa_block_cached__mixer_token_mlp__decode'

def setup_inputs():

    _w = (lambda a: (lambda t: t.to(torch.bfloat16) if t.is_floating_point() else t)(torch.as_tensor(a)))
    def _A_setup():
        B, Sq, D = 8, 1, 512
        Hq, Hkv, Sk, Dh = 32, 8, 4096, 128
        assert Hq % Hkv == 0, (Hq, Hkv)
        return {
            "x": _w((lambda *s: torch.randn(*s, dtype=torch.bfloat16) * 0.05)(B, Sq, D)),
            "k_cache": _w((lambda *s: torch.randn(*s, dtype=torch.bfloat16) * 1.6)(B, Hkv, Sk, Dh)),
            "v_cache": _w((lambda *s: torch.randn(*s, dtype=torch.bfloat16) * 0.8)(B, Hkv, Sk, Dh)),
            "wq": _w((lambda *s: torch.randn(*s, dtype=torch.bfloat16) * 1.6)(D, Hq * Dh) * (D ** -0.5)),
            "wo": _w((lambda *s: torch.randn(*s, dtype=torch.bfloat16) * 0.8)(Hq * Dh, D) * ((Hq * Dh) ** -0.5)),
        }
    _A_in = _A_setup()

    def _B_setup():
        B, S, D, F = 8, 1, 512, 1792
        return {
            "x": _w((lambda *s: torch.randn(*s, dtype=torch.bfloat16) * 0.05)(B, S, D)),
            "w1": _w((lambda *s: torch.randn(*s, dtype=torch.bfloat16) * 0.8)(S, F) * (S ** -0.5)),
            "b1": _w((lambda *s: torch.randn(*s, dtype=torch.bfloat16) * 0.8)(F) * 0.02),
            "w2": _w((lambda *s: torch.randn(*s, dtype=torch.bfloat16) * 0.8)(F, S) * (F ** -0.5)),
            "b2": _w((lambda *s: torch.randn(*s, dtype=torch.bfloat16) * 0.4)(S) * 0.02),
        }
    _B_in = _B_setup()

    return {
        "A_x": _A_in["x"],
        "A_k_cache": _A_in["k_cache"],
        "A_v_cache": _A_in["v_cache"],
        "A_wq": _A_in["wq"],
        "A_wo": _A_in["wo"],
        "B_x": _B_in["x"],
        "B_w1": _B_in["w1"],
        "B_b1": _B_in["b1"],
        "B_w2": _B_in["w2"],
        "B_b2": _B_in["b2"],
    }

def reference(A_x, A_k_cache, A_v_cache, A_wq, A_wo, B_x, B_w1, B_b1, B_w2, B_b2):
    def _A_ref(x, k_cache, v_cache, wq, wo):
        B, Sq, D = x.shape
        Hq, Dh = 32, 128
        Hkv = k_cache.shape[1]
        rep = Hq // Hkv
        q = (lambda x, *d: x.permute(*d))((x @ wq).reshape(B, Sq, Hq, Dh), 0, 2, 1, 3)
        k = (lambda x, n, axis: torch.repeat_interleave(x, n, dim=axis))(k_cache, rep, axis=1)
        v = (lambda x, n, axis: torch.repeat_interleave(x, n, dim=axis))(v_cache, rep, axis=1)
        scores = torch.einsum("bhqd,bhkd->bhqk", q, k) * (Dh ** -0.5)
        p = _softmax(scores, axis=-1)
        o = torch.einsum("bhqk,bhkd->bhqd", p, v)
        return (lambda x, *d: x.permute(*d))(o, 0, 2, 1, 3).reshape(B, Sq, Hq * Dh) @ wo

    def _B_ref(x, w1, b1, w2, b2):
        B, S, D = x.shape
        h = _layernorm(x, axis=-1)
        u = torch.einsum("bsd,sf->bdf", h, w1) + b1
        u = _gelu(u)
        y = torch.einsum("bdf,fs->bds", u, w2) + b2
        return (lambda x, *d: x.permute(*d))(y, 0, 2, 1)

    x = A_x
    h = x + _A_ref(_layernorm(x, axis=-1), A_k_cache, A_v_cache, A_wq, A_wo)
    h2 = h + _B_ref(_layernorm(h, axis=-1), B_w1, B_b1, B_w2, B_b2)
    return h2
```

```asm
; @launch grid=(256,1,1) block=(768,1,1) lds=163840
.amdgcn_target "amdgcn-amd-amdhsa--gfx950"
.text
.globl sequential_preLN__gqa_block_cached__mixer_token_mlp__decode_kernel
.p2align 8
.type sequential_preLN__gqa_block_cached__mixer_token_mlp__decode_kernel,@function
sequential_preLN__gqa_block_cached__mixer_token_mlp__decode_kernel:
    s_cmp_ge_u32 s2, 256
    s_cbranch_scc1 L_end
    s_mov_b32 s33, s2
    s_load_dwordx16 s[64:79], s[0:1], 0
    s_load_dwordx8 s[80:87], s[0:1], 64
    s_load_dwordx2 s[88:89], s[0:1], 96
    v_and_b32 v1, 63, v0
    v_lshrrev_b32 v4, 6, v0
    v_lshrrev_b32 v2, 4, v1
    v_and_b32 v3, 15, v1
    v_readfirstlane_b32 s3, v4
    s_and_b32 s44, s2, 7
    s_lshr_b32 s45, s2, 5
    s_xor_b32 s101, s45, 0
    s_lshr_b32 s101, s33, 5
    s_and_b32 s94, s33, 7
    s_bfe_u32 s95, s33, 0x20003
    s_lshr_b32 s46, s2, 3
    s_and_b32 s46, s46, 3
    s_and_b32 s45, s33, 7
    s_bfe_u32 s44, s33, 0x30003
    s_lshr_b32 s46, s33, 6
    s_mov_b32 s47, 0x05040100
    s_mov_b32 s48, 0x07060302
    s_cmp_lg_u32 s3, 8
    s_cbranch_scc1 L_noinit
    v_mov_b32 v4, 0
    v_lshlrev_b32 v5, 2, v1
    v_add_u32 v5, 132096, v5
    s_mov_b64 exec, 0xffff
    ds_write_b32 v5, v4
    s_mov_b64 exec, -1
L_noinit:
    s_waitcnt lgkmcnt(0)
    s_mov_b32 s4, s66
    s_and_b32 s5, s67, 0xffff
    s_mov_b32 s6, 67108864
    s_mov_b32 s7, 0x00020000
    s_mov_b32 s8, s68
    s_and_b32 s9, s69, 0xffff
    s_mov_b32 s10, 67108864
    s_mov_b32 s11, 0x00020000
    s_mov_b32 s12, s88
    s_and_b32 s13, s89, 0xffff
    s_mov_b32 s14, 268435456
    s_mov_b32 s15, 0x00020000
    s_mov_b32 s16, s64
    s_and_b32 s17, s65, 0xffff
    s_mov_b32 s18, 8192
    s_mov_b32 s19, 0x00020000
    s_mov_b32 s20, s70
    s_and_b32 s21, s71, 0xffff
    s_mov_b32 s22, 4194304
    s_mov_b32 s23, 0x00020000
    s_mov_b32 s24, s72
    s_and_b32 s25, s73, 0xffff
    s_mov_b32 s26, 4194304
    s_mov_b32 s27, 0x00020000
    s_mov_b32 s28, s84
    s_and_b32 s29, s85, 0xffff
    s_mov_b32 s30, 8192
    s_mov_b32 s31, 0x00020000
    s_mov_b64 s[36:37], s[76:77]
    s_mov_b64 s[38:39], s[78:79]
    s_mov_b64 s[40:41], s[80:81]
    s_mov_b64 s[42:43], s[82:83]
    s_add_u32 s64, s88, 136839168
    s_addc_u32 s65, s89, 0
    s_load_dword s100, s[64:65], 0
    s_cmp_ge_u32 s3, 8
    s_cbranch_scc1 L_service
    s_lshl_b32 s50, s45, 3
    s_add_u32 s50, s50, s44
    s_lshl_b32 s50, s50, 20
    s_lshl_b32 s51, s46, 18
    s_add_u32 s50, s50, s51
    s_lshl_b32 s51, s3, 13
    s_add_u32 s52, s50, s51
    s_xor_b32 s53, s52, 65536
    s_xor_b32 s54, s52, 131072
    s_xor_b32 s55, s52, 196608
    s_lshl_b32 s56, s3, 14
    v_lshlrev_b32 v16, 2, v2
    v_xor_b32 v16, v16, v3
    v_xor_b32 v17, 0, v16
    v_lshlrev_b32 v17, 4, v17
    v_lshl_add_u32 v4, v2, 8, v17
    v_xor_b32 v17, 1, v16
    v_lshlrev_b32 v17, 4, v17
    v_lshl_add_u32 v5, v2, 8, v17
    v_xor_b32 v17, 2, v16
    v_lshlrev_b32 v17, 4, v17
    v_lshl_add_u32 v6, v2, 8, v17
    v_xor_b32 v17, 3, v16
    v_lshlrev_b32 v17, 4, v17
    v_lshl_add_u32 v7, v2, 8, v17
    v_lshlrev_b32 v12, 4, v1
    s_memrealtime s[98:99]
    s_barrier
    s_add_u32 m0, s56, 0
    s_nop 0
    buffer_load_dwordx4 v4, s[4:7], s52 offen offset:0 nt lds
    buffer_load_dwordx4 v5, s[4:7], s52 offen offset:1024 nt lds
Ltp_1:
    s_memrealtime s[96:97]
    s_waitcnt lgkmcnt(0)
    s_sub_u32 s96, s96, s98
    s_cmp_ge_u32 s96, 32
    s_cbranch_scc1 Ltd_2
    s_sleep 1
    s_branch Ltp_1
Ltd_2:
    buffer_load_dwordx4 v6, s[4:7], s52 offen offset:2048 nt lds
Ltp_3:
    s_memrealtime s[96:97]
    s_waitcnt lgkmcnt(0)
    s_sub_u32 s96, s96, s98
    s_cmp_ge_u32 s96, 64
    s_cbranch_scc1 Ltd_4
    s_sleep 1
    s_branch Ltp_3
Ltd_4:
    buffer_load_dwordx4 v7, s[4:7], s52 offen offset:3072 nt lds
    s_add_u32 m0, s56, 4096
    s_add_u32 s57, s52, 4096
Ltp_5:
    s_memrealtime s[96:97]
    s_waitcnt lgkmcnt(0)
    s_sub_u32 s96, s96, s98
    s_cmp_ge_u32 s96, 96
    s_cbranch_scc1 Ltd_6
    s_sleep 1
    s_branch Ltp_5
Ltd_6:
    buffer_load_dwordx4 v4, s[4:7], s57 offen offset:0 nt lds
Ltp_7:
    s_memrealtime s[96:97]
    s_waitcnt lgkmcnt(0)
    s_sub_u32 s96, s96, s98
    s_cmp_ge_u32 s96, 128
    s_cbranch_scc1 Ltd_8
    s_sleep 1
    s_branch Ltp_7
Ltd_8:
    buffer_load_dwordx4 v5, s[4:7], s57 offen offset:1024 nt lds
Ltp_9:
    s_memrealtime s[96:97]
    s_waitcnt lgkmcnt(0)
    s_sub_u32 s96, s96, s98
    s_cmp_ge_u32 s96, 160
    s_cbranch_scc1 Ltd_10
    s_sleep 1
    s_branch Ltp_9
Ltd_10:
    buffer_load_dwordx4 v6, s[4:7], s57 offen offset:2048 nt lds
Ltp_11:
    s_memrealtime s[96:97]
    s_waitcnt lgkmcnt(0)
    s_sub_u32 s96, s96, s98
    s_cmp_ge_u32 s96, 192
    s_cbranch_scc1 Ltd_12
    s_sleep 1
    s_branch Ltp_11
Ltd_12:
    buffer_load_dwordx4 v7, s[4:7], s57 offen offset:3072 nt lds
    s_add_u32 m0, s56, 8192
Ltp_13:
    s_memrealtime s[96:97]
    s_waitcnt lgkmcnt(0)
    s_sub_u32 s96, s96, s98
    s_cmp_ge_u32 s96, 224
    s_cbranch_scc1 Ltd_14
    s_sleep 1
    s_branch Ltp_13
Ltd_14:
    buffer_load_dwordx4 v4, s[4:7], s53 offen offset:0 nt lds
Ltp_15:
    s_memrealtime s[96:97]
    s_waitcnt lgkmcnt(0)
    s_sub_u32 s96, s96, s98
    s_cmp_ge_u32 s96, 256
    s_cbranch_scc1 Ltd_16
    s_sleep 1
    s_branch Ltp_15
Ltd_16:
    buffer_load_dwordx4 v5, s[4:7], s53 offen offset:1024 nt lds
Ltp_17:
    s_memrealtime s[96:97]
    s_waitcnt lgkmcnt(0)
    s_sub_u32 s96, s96, s98
    s_cmp_ge_u32 s96, 288
    s_cbranch_scc1 Ltd_18
    s_sleep 1
    s_branch Ltp_17
Ltd_18:
    buffer_load_dwordx4 v6, s[4:7], s53 offen offset:2048 nt lds
Ltp_19:
    s_memrealtime s[96:97]
    s_waitcnt lgkmcnt(0)
    s_sub_u32 s96, s96, s98
    s_cmp_ge_u32 s96, 320
    s_cbranch_scc1 Ltd_20
    s_sleep 1
    s_branch Ltp_19
Ltd_20:
    buffer_load_dwordx4 v7, s[4:7], s53 offen offset:3072 nt lds
    s_add_u32 m0, s56, 12288
    s_add_u32 s57, s53, 4096
Ltp_21:
    s_memrealtime s[96:97]
    s_waitcnt lgkmcnt(0)
    s_sub_u32 s96, s96, s98
    s_cmp_ge_u32 s96, 352
    s_cbranch_scc1 Ltd_22
    s_sleep 1
    s_branch Ltp_21
Ltd_22:
    buffer_load_dwordx4 v4, s[4:7], s57 offen offset:0 nt lds
Ltp_23:
    s_memrealtime s[96:97]
    s_waitcnt lgkmcnt(0)
    s_sub_u32 s96, s96, s98
    s_cmp_ge_u32 s96, 384
    s_cbranch_scc1 Ltd_24
    s_sleep 1
    s_branch Ltp_23
Ltd_24:
    buffer_load_dwordx4 v5, s[4:7], s57 offen offset:1024 nt lds
Ltp_25:
    s_memrealtime s[96:97]
    s_waitcnt lgkmcnt(0)
    s_sub_u32 s96, s96, s98
    s_cmp_ge_u32 s96, 416
    s_cbranch_scc1 Ltd_26
    s_sleep 1
    s_branch Ltp_25
Ltd_26:
    buffer_load_dwordx4 v6, s[4:7], s57 offen offset:2048 nt lds
Ltp_27:
    s_memrealtime s[96:97]
    s_waitcnt lgkmcnt(0)
    s_sub_u32 s96, s96, s98
    s_cmp_ge_u32 s96, 448
    s_cbranch_scc1 Ltd_28
    s_sleep 1
    s_branch Ltp_27
Ltd_28:
    buffer_load_dwordx4 v7, s[4:7], s57 offen offset:3072 nt lds
    s_add_u32 s57, s52, 4096
    s_waitcnt vmcnt(15)
Ltp_29:
    s_memrealtime s[96:97]
    s_waitcnt lgkmcnt(0)
    s_sub_u32 s96, s96, s98
    s_cmp_ge_u32 s96, 480
    s_cbranch_scc1 Ltd_30
    s_sleep 1
    s_branch Ltp_29
Ltd_30:
    buffer_load_dwordx4 v[100:103], v12, s[8:11], s52 offen offset:0 nt
    s_waitcnt vmcnt(15)
Ltp_31:
    s_memrealtime s[96:97]
    s_waitcnt lgkmcnt(0)
    s_sub_u32 s96, s96, s98
    s_cmp_ge_u32 s96, 512
    s_cbranch_scc1 Ltd_32
    s_sleep 1
    s_branch Ltp_31
Ltd_32:
    buffer_load_dwordx4 v[104:107], v12, s[8:11], s52 offen offset:1024 nt
    s_waitcnt vmcnt(15)
Ltp_33:
    s_memrealtime s[96:97]
    s_waitcnt lgkmcnt(0)
    s_sub_u32 s96, s96, s98
    s_cmp_ge_u32 s96, 544
    s_cbranch_scc1 Ltd_34
    s_sleep 1
    s_branch Ltp_33
Ltd_34:
    buffer_load_dwordx4 v[108:111], v12, s[8:11], s52 offen offset:2048 nt
    s_waitcnt vmcnt(15)
Ltp_35:
    s_memrealtime s[96:97]
    s_waitcnt lgkmcnt(0)
    s_sub_u32 s96, s96, s98
    s_cmp_ge_u32 s96, 576
    s_cbranch_scc1 Ltd_36
    s_sleep 1
    s_branch Ltp_35
Ltd_36:
    buffer_load_dwordx4 v[112:115], v12, s[8:11], s52 offen offset:3072 nt
    s_waitcnt vmcnt(15)
Ltp_37:
    s_memrealtime s[96:97]
    s_waitcnt lgkmcnt(0)
    s_sub_u32 s96, s96, s98
    s_cmp_ge_u32 s96, 608
    s_cbranch_scc1 Ltd_38
    s_sleep 1
    s_branch Ltp_37
Ltd_38:
    buffer_load_dwordx4 v[116:119], v12, s[8:11], s57 offen offset:0 nt
    s_waitcnt vmcnt(15)
Ltp_39:
    s_memrealtime s[96:97]
    s_waitcnt lgkmcnt(0)
    s_sub_u32 s96, s96, s98
    s_cmp_ge_u32 s96, 640
    s_cbranch_scc1 Ltd_40
    s_sleep 1
    s_branch Ltp_39
Ltd_40:
    buffer_load_dwordx4 v[120:123], v12, s[8:11], s57 offen offset:1024 nt
    s_waitcnt vmcnt(15)
Ltp_41:
    s_memrealtime s[96:97]
    s_waitcnt lgkmcnt(0)
    s_sub_u32 s96, s96, s98
    s_cmp_ge_u32 s96, 672
    s_cbranch_scc1 Ltd_42
    s_sleep 1
    s_branch Ltp_41
Ltd_42:
    buffer_load_dwordx4 v[124:127], v12, s[8:11], s57 offen offset:2048 nt
    s_waitcnt vmcnt(15)
Ltp_43:
    s_memrealtime s[96:97]
    s_waitcnt lgkmcnt(0)
    s_sub_u32 s96, s96, s98
    s_cmp_ge_u32 s96, 704
    s_cbranch_scc1 Ltd_44
    s_sleep 1
    s_branch Ltp_43
Ltd_44:
    buffer_load_dwordx4 v[128:131], v12, s[8:11], s57 offen offset:3072 nt
    s_add_u32 s57, s53, 4096
    s_waitcnt vmcnt(15)
Ltp_45:
    s_memrealtime s[96:97]
    s_waitcnt lgkmcnt(0)
    s_sub_u32 s96, s96, s98
    s_cmp_ge_u32 s96, 736
    s_cbranch_scc1 Ltd_46
    s_sleep 1
    s_branch Ltp_45
Ltd_46:
    buffer_load_dwordx4 v[132:135], v12, s[8:11], s53 offen offset:0 nt
    s_waitcnt vmcnt(15)
Ltp_47:
    s_memrealtime s[96:97]
    s_waitcnt lgkmcnt(0)
    s_sub_u32 s96, s96, s98
    s_cmp_ge_u32 s96, 768
    s_cbranch_scc1 Ltd_48
    s_sleep 1
    s_branch Ltp_47
Ltd_48:
    buffer_load_dwordx4 v[136:139], v12, s[8:11], s53 offen offset:1024 nt
    s_waitcnt vmcnt(15)
Ltp_49:
    s_memrealtime s[96:97]
    s_waitcnt lgkmcnt(0)
    s_sub_u32 s96, s96, s98
    s_cmp_ge_u32 s96, 800
    s_cbranch_scc1 Ltd_50
    s_sleep 1
    s_branch Ltp_49
Ltd_50:
    buffer_load_dwordx4 v[140:143], v12, s[8:11], s53 offen offset:2048 nt
    s_waitcnt vmcnt(15)
Ltp_51:
    s_memrealtime s[96:97]
    s_waitcnt lgkmcnt(0)
    s_sub_u32 s96, s96, s98
    s_cmp_ge_u32 s96, 832
    s_cbranch_scc1 Ltd_52
    s_sleep 1
    s_branch Ltp_51
Ltd_52:
    buffer_load_dwordx4 v[144:147], v12, s[8:11], s53 offen offset:3072 nt
    s_waitcnt vmcnt(15)
Ltp_53:
    s_memrealtime s[96:97]
    s_waitcnt lgkmcnt(0)
    s_sub_u32 s96, s96, s98
    s_cmp_ge_u32 s96, 864
    s_cbranch_scc1 Ltd_54
    s_sleep 1
    s_branch Ltp_53
Ltd_54:
    buffer_load_dwordx4 v[148:151], v12, s[8:11], s57 offen offset:0 nt
    s_waitcnt vmcnt(15)
Ltp_55:
    s_memrealtime s[96:97]
    s_waitcnt lgkmcnt(0)
    s_sub_u32 s96, s96, s98
    s_cmp_ge_u32 s96, 896
    s_cbranch_scc1 Ltd_56
    s_sleep 1
    s_branch Ltp_55
Ltd_56:
    buffer_load_dwordx4 v[152:155], v12, s[8:11], s57 offen offset:1024 nt
    s_waitcnt vmcnt(15)
Ltp_57:
    s_memrealtime s[96:97]
    s_waitcnt lgkmcnt(0)
    s_sub_u32 s96, s96, s98
    s_cmp_ge_u32 s96, 928
    s_cbranch_scc1 Ltd_58
    s_sleep 1
    s_branch Ltp_57
Ltd_58:
    buffer_load_dwordx4 v[156:159], v12, s[8:11], s57 offen offset:2048 nt
    s_waitcnt vmcnt(15)
Ltp_59:
    s_memrealtime s[96:97]
    s_waitcnt lgkmcnt(0)
    s_sub_u32 s96, s96, s98
    s_cmp_ge_u32 s96, 960
    s_cbranch_scc1 Ltd_60
    s_sleep 1
    s_branch Ltp_59
Ltd_60:
    buffer_load_dwordx4 v[160:163], v12, s[8:11], s57 offen offset:3072 nt
    v_and_b32 v16, 3, v3
    v_lshlrev_b32 v16, 2, v16
    v_lshrrev_b32 v17, 2, v3
    v_add_u32 v16, v16, v17
    v_lshlrev_b32 v16, 8, v16
    v_add_u32 v16, s56, v16
    v_or_b32 v17, 0, v2
    v_xor_b32 v17, v17, v3
    v_lshl_add_u32 v8, v17, 4, v16
    v_or_b32 v17, 4, v2
    v_xor_b32 v17, v17, v3
    v_lshl_add_u32 v9, v17, 4, v16
    v_or_b32 v17, 8, v2
    v_xor_b32 v17, v17, v3
    v_lshl_add_u32 v10, v17, 4, v16
    v_or_b32 v17, 12, v2
    v_xor_b32 v17, v17, v3
    v_lshl_add_u32 v11, v17, 4, v16
    v_and_b32 v16, 3, v3
    v_lshlrev_b32 v16, 8, v16
    v_lshl_add_u32 v19, v2, 4, v16
    v_add_u32 v19, 131072, v19
    v_mov_b32 v18, 132096
    s_waitcnt lgkmcnt(0)
    s_mul_i32 s50, s100, 0x9E3779B1
    s_add_u32 s50, s50, 0x85EBCA6B
    s_and_b32 s90, s50, 0x3ff
    s_lshr_b32 s91, s50, 10
    s_and_b32 s91, s91, 0x3ff
    s_lshr_b32 s92, s50, 20
    s_and_b32 s92, s92, 0x3ff
    s_lshr_b32 s93, s50, 30
    s_lshl_b32 s93, s93, 8
    s_andn2_b32 s50, 0xff, s50
    s_or_b32 s93, s93, s50
    s_mov_b32 s49, 0
Lspin_61:
    ds_read_b32 v16, v18 offset:0
    s_waitcnt lgkmcnt(0)
    v_readfirstlane_b32 s50, v16
    s_nop 0
    s_cmp_eq_u32 s50, 4
    s_cbranch_scc1 Lspun_62
    s_sleep 1
    s_add_u32 s49, s49, 1
    s_cmp_lt_u32 s49, 4194304
    s_cbranch_scc1 Lspin_61
Lspun_62:
    ds_read_b32 v16, v18 offset:36
    s_waitcnt lgkmcnt(0)
    v_readfirstlane_b32 s99, v16
    ds_read_b128 v[20:23], v19 offset:0
    ds_read_b128 v[24:27], v19 offset:64
    ds_read_b128 v[28:31], v19 offset:128
    ds_read_b128 v[32:35], v19 offset:192
    s_waitcnt vmcnt(24)
    ds_read_b128 v[36:39], v8 offset:0
    ds_read_b128 v[40:43], v9 offset:0
    ds_read_b128 v[44:47], v10 offset:0
    ds_read_b128 v[48:51], v11 offset:0
    s_waitcnt lgkmcnt(3)
    v_mfma_f32_16x16x32_bf16 v[52:55], v[36:39], v[20:23], 0
    s_waitcnt lgkmcnt(2)
    v_mfma_f32_16x16x32_bf16 v[52:55], v[40:43], v[24:27], v[52:55]
    s_waitcnt lgkmcnt(1)
    v_mfma_f32_16x16x32_bf16 v[52:55], v[44:47], v[28:31], v[52:55]
    s_waitcnt lgkmcnt(0)
    v_mfma_f32_16x16x32_bf16 v[52:55], v[48:51], v[32:35], v[52:55]
    ds_read_b128 v[36:39], v8 offset:4096
    ds_read_b128 v[40:43], v9 offset:4096
    ds_read_b128 v[44:47], v10 offset:4096
    ds_read_b128 v[48:51], v11 offset:4096
    s_waitcnt lgkmcnt(3)
    v_mfma_f32_16x16x32_bf16 v[56:59], v[36:39], v[20:23], 0
    s_waitcnt lgkmcnt(2)
    v_mfma_f32_16x16x32_bf16 v[56:59], v[40:43], v[24:27], v[56:59]
    s_waitcnt lgkmcnt(1)
    v_mfma_f32_16x16x32_bf16 v[56:59], v[44:47], v[28:31], v[56:59]
    s_waitcnt lgkmcnt(0)
    v_mfma_f32_16x16x32_bf16 v[56:59], v[48:51], v[32:35], v[56:59]
    s_add_u32 m0, s56, 0
    s_waitcnt vmcnt(15)
    s_sub_u32 s98, s98, s99
Ltp_63:
    s_memrealtime s[96:97]
    s_waitcnt lgkmcnt(0)
    s_sub_u32 s96, s96, s98
    s_cmp_ge_u32 s96, 992
    s_cbranch_scc1 Ltd_64
    s_sleep 1
    s_branch Ltp_63
Ltd_64:
    buffer_load_dwordx4 v4, s[4:7], s54 offen offset:0 nt lds
    s_waitcnt vmcnt(15)
Ltp_65:
    s_memrealtime s[96:97]
    s_waitcnt lgkmcnt(0)
    s_sub_u32 s96, s96, s98
    s_cmp_ge_u32 s96, 1024
    s_cbranch_scc1 Ltd_66
    s_sleep 1
    s_branch Ltp_65
Ltd_66:
    buffer_load_dwordx4 v5, s[4:7], s54 offen offset:1024 nt lds
    s_waitcnt vmcnt(15)
Ltp_67:
    s_memrealtime s[96:97]
    s_waitcnt lgkmcnt(0)
    s_sub_u32 s96, s96, s98
    s_cmp_ge_u32 s96, 1056
    s_cbranch_scc1 Ltd_68
    s_sleep 1
    s_branch Ltp_67
Ltd_68:
    buffer_load_dwordx4 v6, s[4:7], s54 offen offset:2048 nt lds
    s_waitcnt vmcnt(15)
Ltp_69:
    s_memrealtime s[96:97]
    s_waitcnt lgkmcnt(0)
    s_sub_u32 s96, s96, s98
    s_cmp_ge_u32 s96, 1088
    s_cbranch_scc1 Ltd_70
    s_sleep 1
    s_branch Ltp_69
Ltd_70:
    buffer_load_dwordx4 v7, s[4:7], s54 offen offset:3072 nt lds
    s_add_u32 m0, s56, 4096
    s_add_u32 s57, s54, 4096
    s_waitcnt vmcnt(15)
    s_sub_u32 s98, s98, s99
Ltp_71:
    s_memrealtime s[96:97]
    s_waitcnt lgkmcnt(0)
    s_sub_u32 s96, s96, s98
    s_cmp_ge_u32 s96, 1120
    s_cbranch_scc1 Ltd_72
    s_sleep 1
    s_branch Ltp_71
Ltd_72:
    buffer_load_dwordx4 v4, s[4:7], s57 offen offset:0 nt lds
    s_waitcnt vmcnt(15)
Ltp_73:
    s_memrealtime s[96:97]
    s_waitcnt lgkmcnt(0)
    s_sub_u32 s96, s96, s98
    s_cmp_ge_u32 s96, 1152
    s_cbranch_scc1 Ltd_74
    s_sleep 1
    s_branch Ltp_73
Ltd_74:
    buffer_load_dwordx4 v5, s[4:7], s57 offen offset:1024 nt lds
    s_waitcnt vmcnt(15)
Ltp_75:
    s_memrealtime s[96:97]
    s_waitcnt lgkmcnt(0)
    s_sub_u32 s96, s96, s98
    s_cmp_ge_u32 s96, 1184
    s_cbranch_scc1 Ltd_76
    s_sleep 1
    s_branch Ltp_75
Ltd_76:
    buffer_load_dwordx4 v6, s[4:7], s57 offen offset:2048 nt lds
    s_waitcnt vmcnt(15)
Ltp_77:
    s_memrealtime s[96:97]
    s_waitcnt lgkmcnt(0)
    s_sub_u32 s96, s96, s98
    s_cmp_ge_u32 s96, 1216
    s_cbranch_scc1 Ltd_78
    s_sleep 1
    s_branch Ltp_77
Ltd_78:
    buffer_load_dwordx4 v7, s[4:7], s57 offen offset:3072 nt lds
    s_waitcnt vmcnt(24)
    ds_read_b128 v[36:39], v8 offset:8192
    ds_read_b128 v[40:43], v9 offset:8192
    ds_read_b128 v[44:47], v10 offset:8192
    ds_read_b128 v[48:51], v11 offset:8192
    s_waitcnt lgkmcnt(3)
    v_mfma_f32_16x16x32_bf16 v[60:63], v[36:39], v[20:23], 0
    s_waitcnt lgkmcnt(2)
    v_mfma_f32_16x16x32_bf16 v[60:63], v[40:43], v[24:27], v[60:63]
    s_waitcnt lgkmcnt(1)
    v_mfma_f32_16x16x32_bf16 v[60:63], v[44:47], v[28:31], v[60:63]
    s_waitcnt lgkmcnt(0)
    v_mfma_f32_16x16x32_bf16 v[60:63], v[48:51], v[32:35], v[60:63]
    ds_read_b128 v[36:39], v8 offset:12288
    ds_read_b128 v[40:43], v9 offset:12288
    ds_read_b128 v[44:47], v10 offset:12288
    ds_read_b128 v[48:51], v11 offset:12288
    s_waitcnt lgkmcnt(3)
    v_mfma_f32_16x16x32_bf16 v[64:67], v[36:39], v[20:23], 0
    s_waitcnt lgkmcnt(2)
    v_mfma_f32_16x16x32_bf16 v[64:67], v[40:43], v[24:27], v[64:67]
    s_waitcnt lgkmcnt(1)
    v_mfma_f32_16x16x32_bf16 v[64:67], v[44:47], v[28:31], v[64:67]
    s_waitcnt lgkmcnt(0)
    v_mfma_f32_16x16x32_bf16 v[64:67], v[48:51], v[32:35], v[64:67]
    s_add_u32 m0, s56, 8192
    s_waitcnt vmcnt(15)
    s_sub_u32 s98, s98, s99
Ltp_79:
    s_memrealtime s[96:97]
    s_waitcnt lgkmcnt(0)
    s_sub_u32 s96, s96, s98
    s_cmp_ge_u32 s96, 1248
    s_cbranch_scc1 Ltd_80
    s_sleep 1
    s_branch Ltp_79
Ltd_80:
    buffer_load_dwordx4 v4, s[4:7], s55 offen offset:0 nt lds
    s_waitcnt vmcnt(15)
Ltp_81:
    s_memrealtime s[96:97]
    s_waitcnt lgkmcnt(0)
    s_sub_u32 s96, s96, s98
    s_cmp_ge_u32 s96, 1280
    s_cbranch_scc1 Ltd_82
    s_sleep 1
    s_branch Ltp_81
Ltd_82:
    buffer_load_dwordx4 v5, s[4:7], s55 offen offset:1024 nt lds
    s_waitcnt vmcnt(15)
Ltp_83:
    s_memrealtime s[96:97]
    s_waitcnt lgkmcnt(0)
    s_sub_u32 s96, s96, s98
    s_cmp_ge_u32 s96, 1312
    s_cbranch_scc1 Ltd_84
    s_sleep 1
    s_branch Ltp_83
Ltd_84:
    buffer_load_dwordx4 v6, s[4:7], s55 offen offset:2048 nt lds
    s_waitcnt vmcnt(15)
Ltp_85:
    s_memrealtime s[96:97]
    s_waitcnt lgkmcnt(0)
    s_sub_u32 s96, s96, s98
    s_cmp_ge_u32 s96, 1344
    s_cbranch_scc1 Ltd_86
    s_sleep 1
    s_branch Ltp_85
Ltd_86:
    buffer_load_dwordx4 v7, s[4:7], s55 offen offset:3072 nt lds
    s_add_u32 m0, s56, 12288
    s_add_u32 s57, s55, 4096
    s_waitcnt vmcnt(15)
    s_sub_u32 s98, s98, s99
Ltp_87:
    s_memrealtime s[96:97]
    s_waitcnt lgkmcnt(0)
    s_sub_u32 s96, s96, s98
    s_cmp_ge_u32 s96, 1376
    s_cbranch_scc1 Ltd_88
    s_sleep 1
    s_branch Ltp_87
Ltd_88:
    buffer_load_dwordx4 v4, s[4:7], s57 offen offset:0 nt lds
    s_waitcnt vmcnt(15)
Ltp_89:
    s_memrealtime s[96:97]
    s_waitcnt lgkmcnt(0)
    s_sub_u32 s96, s96, s98
    s_cmp_ge_u32 s96, 1408
    s_cbranch_scc1 Ltd_90
    s_sleep 1
    s_branch Ltp_89
Ltd_90:
    buffer_load_dwordx4 v5, s[4:7], s57 offen offset:1024 nt lds
    s_waitcnt vmcnt(15)
Ltp_91:
    s_memrealtime s[96:97]
    s_waitcnt lgkmcnt(0)
    s_sub_u32 s96, s96, s98
    s_cmp_ge_u32 s96, 1440
    s_cbranch_scc1 Ltd_92
    s_sleep 1
    s_branch Ltp_91
Ltd_92:
    buffer_load_dwordx4 v6, s[4:7], s57 offen offset:2048 nt lds
    s_waitcnt vmcnt(15)
Ltp_93:
    s_memrealtime s[96:97]
    s_waitcnt lgkmcnt(0)
    s_sub_u32 s96, s96, s98
    s_cmp_ge_u32 s96, 1472
    s_cbranch_scc1 Ltd_94
    s_sleep 1
    s_branch Ltp_93
Ltd_94:
    buffer_load_dwordx4 v7, s[4:7], s57 offen offset:3072 nt lds
    v_cvt_pk_bf16_f32 v16, v52, v53
    v_lshlrev_b32 v52, 16, v16
    v_and_b32 v53, 0xffff0000, v16
    v_mul_f32 v52, 0x3db504f3, v52
    v_mul_f32 v53, 0x3db504f3, v53
    v_cvt_pk_bf16_f32 v16, v52, v53
    v_lshlrev_b32 v52, 16, v16
    v_and_b32 v53, 0xffff0000, v16
    v_cvt_pk_bf16_f32 v16, v54, v55
    v_lshlrev_b32 v54, 16, v16
    v_and_b32 v55, 0xffff0000, v16
    v_mul_f32 v54, 0x3db504f3, v54
    v_mul_f32 v55, 0x3db504f3, v55
    v_cvt_pk_bf16_f32 v16, v54, v55
    v_lshlrev_b32 v54, 16, v16
    v_and_b32 v55, 0xffff0000, v16
    v_cvt_pk_bf16_f32 v16, v56, v57
    v_lshlrev_b32 v56, 16, v16
    v_and_b32 v57, 0xffff0000, v16
    v_mul_f32 v56, 0x3db504f3, v56
    v_mul_f32 v57, 0x3db504f3, v57
    v_cvt_pk_bf16_f32 v16, v56, v57
    v_lshlrev_b32 v56, 16, v16
    v_and_b32 v57, 0xffff0000, v16
    v_cvt_pk_bf16_f32 v16, v58, v59
    v_lshlrev_b32 v58, 16, v16
    v_and_b32 v59, 0xffff0000, v16
    v_mul_f32 v58, 0x3db504f3, v58
    v_mul_f32 v59, 0x3db504f3, v59
    v_cvt_pk_bf16_f32 v16, v58, v59
    v_lshlrev_b32 v58, 16, v16
    v_and_b32 v59, 0xffff0000, v16
    v_cvt_pk_bf16_f32 v16, v60, v61
    v_lshlrev_b32 v60, 16, v16
    v_and_b32 v61, 0xffff0000, v16
    v_mul_f32 v60, 0x3db504f3, v60
    v_mul_f32 v61, 0x3db504f3, v61
    v_cvt_pk_bf16_f32 v16, v60, v61
    v_lshlrev_b32 v60, 16, v16
    v_and_b32 v61, 0xffff0000, v16
    v_cvt_pk_bf16_f32 v16, v62, v63
    v_lshlrev_b32 v62, 16, v16
    v_and_b32 v63, 0xffff0000, v16
    v_mul_f32 v62, 0x3db504f3, v62
    v_mul_f32 v63, 0x3db504f3, v63
    v_cvt_pk_bf16_f32 v16, v62, v63
    v_lshlrev_b32 v62, 16, v16
    v_and_b32 v63, 0xffff0000, v16
    v_cvt_pk_bf16_f32 v16, v64, v65
    v_lshlrev_b32 v64, 16, v16
    v_and_b32 v65, 0xffff0000, v16
    v_mul_f32 v64, 0x3db504f3, v64
    v_mul_f32 v65, 0x3db504f3, v65
    v_cvt_pk_bf16_f32 v16, v64, v65
    v_lshlrev_b32 v64, 16, v16
    v_and_b32 v65, 0xffff0000, v16
    v_cvt_pk_bf16_f32 v16, v66, v67
    v_lshlrev_b32 v66, 16, v16
    v_and_b32 v67, 0xffff0000, v16
    v_mul_f32 v66, 0x3db504f3, v66
    v_mul_f32 v67, 0x3db504f3, v67
    v_cvt_pk_bf16_f32 v16, v66, v67
    v_lshlrev_b32 v66, 16, v16
    v_and_b32 v67, 0xffff0000, v16
    v_max3_f32 v13, v52, v53, v54
    v_max3_f32 v13, v13, v55, v56
    v_max3_f32 v13, v13, v57, v58
    v_max3_f32 v13, v13, v59, v60
    v_max3_f32 v13, v13, v61, v62
    v_max3_f32 v13, v13, v63, v64
    v_max3_f32 v13, v13, v65, v66
    v_max_f32 v13, v13, v67
    v_mov_b32 v16, v13
    s_nop 1
    v_permlane16_swap_b32 v13, v16
    v_max_f32 v13, v13, v16
    v_mov_b32 v16, v13
    s_nop 1
    v_permlane32_swap_b32 v13, v16
    v_max_f32 v13, v13, v16
    v_mul_f32 v4, 0xbfb8aa3b, v13
    s_mov_b32 s57, 0x3fb8aa3b
    v_fma_f32 v52, v52, s57, v4
    v_exp_f32 v52, v52
    v_fma_f32 v53, v53, s57, v4
    v_exp_f32 v53, v53
    v_fma_f32 v54, v54, s57, v4
    v_exp_f32 v54, v54
    v_fma_f32 v55, v55, s57, v4
    v_exp_f32 v55, v55
    v_fma_f32 v56, v56, s57, v4
    v_exp_f32 v56, v56
    v_fma_f32 v57, v57, s57, v4
    v_exp_f32 v57, v57
    v_fma_f32 v58, v58, s57, v4
    v_exp_f32 v58, v58
    v_fma_f32 v59, v59, s57, v4
    v_exp_f32 v59, v59
    v_fma_f32 v60, v60, s57, v4
    v_exp_f32 v60, v60
    v_fma_f32 v61, v61, s57, v4
    v_exp_f32 v61, v61
    v_fma_f32 v62, v62, s57, v4
    v_exp_f32 v62, v62
    v_fma_f32 v63, v63, s57, v4
    v_exp_f32 v63, v63
    v_fma_f32 v64, v64, s57, v4
    v_exp_f32 v64, v64
    v_fma_f32 v65, v65, s57, v4
    v_exp_f32 v65, v65
    v_fma_f32 v66, v66, s57, v4
    v_exp_f32 v66, v66
    v_fma_f32 v67, v67, s57, v4
    v_exp_f32 v67, v67
    v_mov_b32 v14, v52
    v_add_f32 v14, v14, v53
    v_add_f32 v14, v14, v54
    v_add_f32 v14, v14, v55
    v_add_f32 v14, v14, v56
    v_add_f32 v14, v14, v57
    v_add_f32 v14, v14, v58
    v_add_f32 v14, v14, v59
    v_add_f32 v14, v14, v60
    v_add_f32 v14, v14, v61
    v_add_f32 v14, v14, v62
    v_add_f32 v14, v14, v63
    v_add_f32 v14, v14, v64
    v_add_f32 v14, v14, v65
    v_add_f32 v14, v14, v66
    v_add_f32 v14, v14, v67
    v_cvt_pk_bf16_f32 v52, v52, v53
    v_cvt_pk_bf16_f32 v53, v54, v55
    v_cvt_pk_bf16_f32 v54, v56, v57
    v_cvt_pk_bf16_f32 v55, v58, v59
    v_cvt_pk_bf16_f32 v56, v60, v61
    v_cvt_pk_bf16_f32 v57, v62, v63
    v_cvt_pk_bf16_f32 v58, v64, v65
    v_cvt_pk_bf16_f32 v59, v66, v67
    s_waitcnt vmcnt(24)
    v_perm_b32 v20, v104, v100, s47
    v_perm_b32 v21, v112, v108, s47
    v_perm_b32 v22, v120, v116, s47
    v_perm_b32 v23, v128, v124, s47
    v_perm_b32 v24, v104, v100, s48
    v_perm_b32 v25, v112, v108, s48
    v_perm_b32 v26, v120, v116, s48
    v_perm_b32 v27, v128, v124, s48
    v_mfma_f32_16x16x32_bf16 v[68:71], v[52:55], v[20:23], 0
    s_nop 0
    v_mfma_f32_16x16x32_bf16 v[72:75], v[52:55], v[24:27], 0
    v_perm_b32 v28, v105, v101, s47
    v_perm_b32 v29, v113, v109, s47
    v_perm_b32 v30, v121, v117, s47
    v_perm_b32 v31, v129, v125, s47
    v_perm_b32 v32, v105, v101, s48
    v_perm_b32 v33, v113, v109, s48
    v_perm_b32 v34, v121, v117, s48
    v_perm_b32 v35, v129, v125, s48
    v_mfma_f32_16x16x32_bf16 v[76:79], v[52:55], v[28:31], 0
    s_nop 0
    v_mfma_f32_16x16x32_bf16 v[80:83], v[52:55], v[32:35], 0
    v_perm_b32 v36, v106, v102, s47
    v_perm_b32 v37, v114, v110, s47
    v_perm_b32 v38, v122, v118, s47
    v_perm_b32 v39, v130, v126, s47
    v_perm_b32 v40, v106, v102, s48
    v_perm_b32 v41, v114, v110, s48
    v_perm_b32 v42, v122, v118, s48
    v_perm_b32 v43, v130, v126, s48
    v_mfma_f32_16x16x32_bf16 v[84:87], v[52:55], v[36:39], 0
    s_nop 0
    v_mfma_f32_16x16x32_bf16 v[88:91], v[52:55], v[40:43], 0
    v_perm_b32 v44, v107, v103, s47
    v_perm_b32 v45, v115, v111, s47
    v_perm_b32 v46, v123, v119, s47
    v_perm_b32 v47, v131, v127, s47
    v_perm_b32 v48, v107, v103, s48
    v_perm_b32 v49, v115, v111, s48
    v_perm_b32 v50, v123, v119, s48
    v_perm_b32 v51, v131, v127, s48
    v_mfma_f32_16x16x32_bf16 v[92:95], v[52:55], v[44:47], 0
    s_nop 0
    v_mfma_f32_16x16x32_bf16 v[96:99], v[52:55], v[48:51], 0
    s_add_u32 s57, s54, 4096
    s_waitcnt vmcnt(15)
    s_sub_u32 s98, s98, s99
Ltp_95:
    s_memrealtime s[96:97]
    s_waitcnt lgkmcnt(0)
    s_sub_u32 s96, s96, s98
    s_cmp_ge_u32 s96, 1504
    s_cbranch_scc1 Ltd_96
    s_sleep 1
    s_branch Ltp_95
Ltd_96:
    buffer_load_dwordx4 v[100:103], v12, s[8:11], s54 offen offset:0 nt
    s_waitcnt vmcnt(15)
Ltp_97:
    s_memrealtime s[96:97]
    s_waitcnt lgkmcnt(0)
    s_sub_u32 s96, s96, s98
    s_cmp_ge_u32 s96, 1536
    s_cbranch_scc1 Ltd_98
    s_sleep 1
    s_branch Ltp_97
Ltd_98:
    buffer_load_dwordx4 v[104:107], v12, s[8:11], s54 offen offset:1024 nt
    s_waitcnt vmcnt(15)
Ltp_99:
    s_memrealtime s[96:97]
    s_waitcnt lgkmcnt(0)
    s_sub_u32 s96, s96, s98
    s_cmp_ge_u32 s96, 1568
    s_cbranch_scc1 Ltd_100
    s_sleep 1
    s_branch Ltp_99
Ltd_100:
    buffer_load_dwordx4 v[108:111], v12, s[8:11], s54 offen offset:2048 nt
    s_waitcnt vmcnt(15)
Ltp_101:
    s_memrealtime s[96:97]
    s_waitcnt lgkmcnt(0)
    s_sub_u32 s96, s96, s98
    s_cmp_ge_u32 s96, 1600
    s_cbranch_scc1 Ltd_102
    s_sleep 1
    s_branch Ltp_101
Ltd_102:
    buffer_load_dwordx4 v[112:115], v12, s[8:11], s54 offen offset:3072 nt
    s_waitcnt vmcnt(15)
    s_sub_u32 s98, s98, s99
Ltp_103:
    s_memrealtime s[96:97]
    s_waitcnt lgkmcnt(0)
    s_sub_u32 s96, s96, s98
    s_cmp_ge_u32 s96, 1632
    s_cbranch_scc1 Ltd_104
    s_sleep 1
    s_branch Ltp_103
Ltd_104:
    buffer_load_dwordx4 v[116:119], v12, s[8:11], s57 offen offset:0 nt
    s_waitcnt vmcnt(15)
Ltp_105:
    s_memrealtime s[96:97]
    s_waitcnt lgkmcnt(0)
    s_sub_u32 s96, s96, s98
    s_cmp_ge_u32 s96, 1664
    s_cbranch_scc1 Ltd_106
    s_sleep 1
    s_branch Ltp_105
Ltd_106:
    buffer_load_dwordx4 v[120:123], v12, s[8:11], s57 offen offset:1024 nt
    s_waitcnt vmcnt(15)
Ltp_107:
    s_memrealtime s[96:97]
    s_waitcnt lgkmcnt(0)
    s_sub_u32 s96, s96, s98
    s_cmp_ge_u32 s96, 1696
    s_cbranch_scc1 Ltd_108
    s_sleep 1
    s_branch Ltp_107
Ltd_108:
    buffer_load_dwordx4 v[124:127], v12, s[8:11], s57 offen offset:2048 nt
    s_waitcnt vmcnt(15)
Ltp_109:
    s_memrealtime s[96:97]
    s_waitcnt lgkmcnt(0)
    s_sub_u32 s96, s96, s98
    s_cmp_ge_u32 s96, 1728
    s_cbranch_scc1 Ltd_110
    s_sleep 1
    s_branch Ltp_109
Ltd_110:
    buffer_load_dwordx4 v[128:131], v12, s[8:11], s57 offen offset:3072 nt
    s_waitcnt vmcnt(24)
    v_perm_b32 v20, v136, v132, s47
    v_perm_b32 v21, v144, v140, s47
    v_perm_b32 v22, v152, v148, s47
    v_perm_b32 v23, v160, v156, s47
    v_perm_b32 v24, v136, v132, s48
    v_perm_b32 v25, v144, v140, s48
    v_perm_b32 v26, v152, v148, s48
    v_perm_b32 v27, v160, v156, s48
    v_mfma_f32_16x16x32_bf16 v[68:71], v[56:59], v[20:23], v[68:71]
    s_nop 0
    v_mfma_f32_16x16x32_bf16 v[72:75], v[56:59], v[24:27], v[72:75]
    v_perm_b32 v28, v137, v133, s47
    v_perm_b32 v29, v145, v141, s47
    v_perm_b32 v30, v153, v149, s47
    v_perm_b32 v31, v161, v157, s47
    v_perm_b32 v32, v137, v133, s48
    v_perm_b32 v33, v145, v141, s48
    v_perm_b32 v34, v153, v149, s48
    v_perm_b32 v35, v161, v157, s48
    v_mfma_f32_16x16x32_bf16 v[76:79], v[56:59], v[28:31], v[76:79]
    s_nop 0
    v_mfma_f32_16x16x32_bf16 v[80:83], v[56:59], v[32:35], v[80:83]
    v_perm_b32 v36, v138, v134, s47
    v_perm_b32 v37, v146, v142, s47
    v_perm_b32 v38, v154, v150, s47
    v_perm_b32 v39, v162, v158, s47
    v_perm_b32 v40, v138, v134, s48
    v_perm_b32 v41, v146, v142, s48
    v_perm_b32 v42, v154, v150, s48
    v_perm_b32 v43, v162, v158, s48
    v_mfma_f32_16x16x32_bf16 v[84:87], v[56:59], v[36:39], v[84:87]
    s_nop 0
    v_mfma_f32_16x16x32_bf16 v[88:91], v[56:59], v[40:43], v[88:91]
    v_perm_b32 v44, v139, v135, s47
    v_perm_b32 v45, v147, v143, s47
    v_perm_b32 v46, v155, v151, s47
    v_perm_b32 v47, v163, v159, s47
    v_perm_b32 v48, v139, v135, s48
    v_perm_b32 v49, v147, v143, s48
    v_perm_b32 v50, v155, v151, s48
    v_perm_b32 v51, v163, v159, s48
    v_mfma_f32_16x16x32_bf16 v[92:95], v[56:59], v[44:47], v[92:95]
    s_nop 0
    v_mfma_f32_16x16x32_bf16 v[96:99], v[56:59], v[48:51], v[96:99]
    ds_read_b128 v[20:23], v19 offset:0
    ds_read_b128 v[24:27], v19 offset:64
    ds_read_b128 v[28:31], v19 offset:128
    ds_read_b128 v[32:35], v19 offset:192
    s_waitcnt vmcnt(16)
    ds_read_b128 v[36:39], v8 offset:0
    ds_read_b128 v[40:43], v9 offset:0
    ds_read_b128 v[44:47], v10 offset:0
    ds_read_b128 v[48:51], v11 offset:0
    s_waitcnt lgkmcnt(3)
    v_mfma_f32_16x16x32_bf16 v[52:55], v[36:39], v[20:23], 0
    s_waitcnt lgkmcnt(2)
    v_mfma_f32_16x16x32_bf16 v[52:55], v[40:43], v[24:27], v[52:55]
    s_waitcnt lgkmcnt(1)
    v_mfma_f32_16x16x32_bf16 v[52:55], v[44:47], v[28:31], v[52:55]
    s_waitcnt lgkmcnt(0)
    v_mfma_f32_16x16x32_bf16 v[52:55], v[48:51], v[32:35], v[52:55]
    ds_read_b128 v[36:39], v8 offset:4096
    ds_read_b128 v[40:43], v9 offset:4096
    ds_read_b128 v[44:47], v10 offset:4096
    ds_read_b128 v[48:51], v11 offset:4096
    s_waitcnt lgkmcnt(3)
    v_mfma_f32_16x16x32_bf16 v[56:59], v[36:39], v[20:23], 0
    s_waitcnt lgkmcnt(2)
    v_mfma_f32_16x16x32_bf16 v[56:59], v[40:43], v[24:27], v[56:59]
    s_waitcnt lgkmcnt(1)
    v_mfma_f32_16x16x32_bf16 v[56:59], v[44:47], v[28:31], v[56:59]
    s_waitcnt lgkmcnt(0)
    v_mfma_f32_16x16x32_bf16 v[56:59], v[48:51], v[32:35], v[56:59]
    s_waitcnt vmcnt(15)
    s_sub_u32 s98, s98, s99
Ltp_111:
    s_memrealtime s[96:97]
    s_waitcnt lgkmcnt(0)
    s_sub_u32 s96, s96, s98
    s_cmp_ge_u32 s96, 1760
    s_cbranch_scc1 Ltd_112
    s_sleep 1
    s_branch Ltp_111
Ltd_112:
    buffer_load_dwordx4 v[132:135], v12, s[8:11], s55 offen offset:0 nt
    s_waitcnt vmcnt(15)
Ltp_113:
    s_memrealtime s[96:97]
    s_waitcnt lgkmcnt(0)
    s_sub_u32 s96, s96, s98
    s_cmp_ge_u32 s96, 1792
    s_cbranch_scc1 Ltd_114
    s_sleep 1
    s_branch Ltp_113
Ltd_114:
    buffer_load_dwordx4 v[136:139], v12, s[8:11], s55 offen offset:1024 nt
    s_waitcnt vmcnt(10)
    ds_read_b128 v[36:39], v8 offset:8192
    ds_read_b128 v[40:43], v9 offset:8192
    ds_read_b128 v[44:47], v10 offset:8192
    ds_read_b128 v[48:51], v11 offset:8192
    s_waitcnt lgkmcnt(3)
    v_mfma_f32_16x16x32_bf16 v[60:63], v[36:39], v[20:23], 0
    s_waitcnt lgkmcnt(2)
    v_mfma_f32_16x16x32_bf16 v[60:63], v[40:43], v[24:27], v[60:63]
    s_waitcnt lgkmcnt(1)
    v_mfma_f32_16x16x32_bf16 v[60:63], v[44:47], v[28:31], v[60:63]
    s_waitcnt lgkmcnt(0)
    v_mfma_f32_16x16x32_bf16 v[60:63], v[48:51], v[32:35], v[60:63]
    ds_read_b128 v[36:39], v8 offset:12288
    ds_read_b128 v[40:43], v9 offset:12288
    ds_read_b128 v[44:47], v10 offset:12288
    ds_read_b128 v[48:51], v11 offset:12288
    s_waitcnt lgkmcnt(3)
    v_mfma_f32_16x16x32_bf16 v[64:67], v[36:39], v[20:23], 0
    s_waitcnt lgkmcnt(2)
    v_mfma_f32_16x16x32_bf16 v[64:67], v[40:43], v[24:27], v[64:67]
    s_waitcnt lgkmcnt(1)
    v_mfma_f32_16x16x32_bf16 v[64:67], v[44:47], v[28:31], v[64:67]
    s_waitcnt lgkmcnt(0)
    v_mfma_f32_16x16x32_bf16 v[64:67], v[48:51], v[32:35], v[64:67]
    v_cvt_pk_bf16_f32 v16, v52, v53
    v_lshlrev_b32 v52, 16, v16
    v_and_b32 v53, 0xffff0000, v16
    v_mul_f32 v52, 0x3db504f3, v52
    v_mul_f32 v53, 0x3db504f3, v53
    v_cvt_pk_bf16_f32 v16, v52, v53
    v_lshlrev_b32 v52, 16, v16
    v_and_b32 v53, 0xffff0000, v16
    v_cvt_pk_bf16_f32 v16, v54, v55
    v_lshlrev_b32 v54, 16, v16
    v_and_b32 v55, 0xffff0000, v16
    v_mul_f32 v54, 0x3db504f3, v54
    v_mul_f32 v55, 0x3db504f3, v55
    v_cvt_pk_bf16_f32 v16, v54, v55
    v_lshlrev_b32 v54, 16, v16
    v_and_b32 v55, 0xffff0000, v16
    v_cvt_pk_bf16_f32 v16, v56, v57
    v_lshlrev_b32 v56, 16, v16
    v_and_b32 v57, 0xffff0000, v16
    v_mul_f32 v56, 0x3db504f3, v56
    v_mul_f32 v57, 0x3db504f3, v57
    v_cvt_pk_bf16_f32 v16, v56, v57
    v_lshlrev_b32 v56, 16, v16
    v_and_b32 v57, 0xffff0000, v16
    v_cvt_pk_bf16_f32 v16, v58, v59
    v_lshlrev_b32 v58, 16, v16
    v_and_b32 v59, 0xffff0000, v16
    v_mul_f32 v58, 0x3db504f3, v58
    v_mul_f32 v59, 0x3db504f3, v59
    v_cvt_pk_bf16_f32 v16, v58, v59
    v_lshlrev_b32 v58, 16, v16
    v_and_b32 v59, 0xffff0000, v16
    v_cvt_pk_bf16_f32 v16, v60, v61
    v_lshlrev_b32 v60, 16, v16
    v_and_b32 v61, 0xffff0000, v16
    v_mul_f32 v60, 0x3db504f3, v60
    v_mul_f32 v61, 0x3db504f3, v61
    v_cvt_pk_bf16_f32 v16, v60, v61
    v_lshlrev_b32 v60, 16, v16
    v_and_b32 v61, 0xffff0000, v16
    v_cvt_pk_bf16_f32 v16, v62, v63
    v_lshlrev_b32 v62, 16, v16
    v_and_b32 v63, 0xffff0000, v16
    v_mul_f32 v62, 0x3db504f3, v62
    v_mul_f32 v63, 0x3db504f3, v63
    v_cvt_pk_bf16_f32 v16, v62, v63
    v_lshlrev_b32 v62, 16, v16
    v_and_b32 v63, 0xffff0000, v16
    v_cvt_pk_bf16_f32 v16, v64, v65
    v_lshlrev_b32 v64, 16, v16
    v_and_b32 v65, 0xffff0000, v16
    v_mul_f32 v64, 0x3db504f3, v64
    v_mul_f32 v65, 0x3db504f3, v65
    v_cvt_pk_bf16_f32 v16, v64, v65
    v_lshlrev_b32 v64, 16, v16
    v_and_b32 v65, 0xffff0000, v16
    v_cvt_pk_bf16_f32 v16, v66, v67
    v_lshlrev_b32 v66, 16, v16
    v_and_b32 v67, 0xffff0000, v16
    v_mul_f32 v66, 0x3db504f3, v66
    v_mul_f32 v67, 0x3db504f3, v67
    v_cvt_pk_bf16_f32 v16, v66, v67
    v_lshlrev_b32 v66, 16, v16
    v_and_b32 v67, 0xffff0000, v16
    s_waitcnt vmcnt(15)
Ltp_115:
    s_memrealtime s[96:97]
    s_waitcnt lgkmcnt(0)
    s_sub_u32 s96, s96, s98
    s_cmp_ge_u32 s96, 1824
    s_cbranch_scc1 Ltd_116
    s_sleep 1
    s_branch Ltp_115
Ltd_116:
    buffer_load_dwordx4 v[140:143], v12, s[8:11], s55 offen offset:2048 nt
    s_waitcnt vmcnt(15)
Ltp_117:
    s_memrealtime s[96:97]
    s_waitcnt lgkmcnt(0)
    s_sub_u32 s96, s96, s98
    s_cmp_ge_u32 s96, 1856
    s_cbranch_scc1 Ltd_118
    s_sleep 1
    s_branch Ltp_117
Ltd_118:
    buffer_load_dwordx4 v[144:147], v12, s[8:11], s55 offen offset:3072 nt
    v_max3_f32 v15, v52, v53, v54
    v_max3_f32 v15, v15, v55, v56
    v_max3_f32 v15, v15, v57, v58
    v_max3_f32 v15, v15, v59, v60
    v_max3_f32 v15, v15, v61, v62
    v_max3_f32 v15, v15, v63, v64
    v_max3_f32 v15, v15, v65, v66
    v_max_f32 v15, v15, v67
    v_mov_b32 v16, v15
    s_nop 1
    v_permlane16_swap_b32 v15, v16
    v_max_f32 v15, v15, v16
    v_mov_b32 v16, v15
    s_nop 1
    v_permlane32_swap_b32 v15, v16
    v_max_f32 v15, v15, v16
    v_max_f32 v15, v15, v13
    v_and_b32 v16, 3, v1
    v_lshlrev_b32 v16, 2, v16
    v_add_u32 v16, 132224, v16
    s_lshl_b32 s57, s3, 4
    v_add_u32 v17, s57, v16
    v_sub_f32 v20, v13, v15
    v_mul_f32 v20, 0x3fb8aa3b, v20
    v_exp_f32 v20, v20
    v_mov_b32 v13, v15
    v_mul_f32 v14, v14, v20
    v_mov_b32 v15, v20
    v_mul_f32 v4, 0xbfb8aa3b, v13
    s_mov_b32 s57, 0x3fb8aa3b
    v_fma_f32 v52, v52, s57, v4
    v_exp_f32 v52, v52
    v_fma_f32 v53, v53, s57, v4
    v_exp_f32 v53, v53
    v_fma_f32 v54, v54, s57, v4
    v_exp_f32 v54, v54
    v_fma_f32 v55, v55, s57, v4
    v_exp_f32 v55, v55
    v_fma_f32 v56, v56, s57, v4
    v_exp_f32 v56, v56
    v_fma_f32 v57, v57, s57, v4
    v_exp_f32 v57, v57
    v_fma_f32 v58, v58, s57, v4
    v_exp_f32 v58, v58
    v_fma_f32 v59, v59, s57, v4
    v_exp_f32 v59, v59
    v_fma_f32 v60, v60, s57, v4
    v_exp_f32 v60, v60
    v_fma_f32 v61, v61, s57, v4
    v_exp_f32 v61, v61
    v_fma_f32 v62, v62, s57, v4
    v_exp_f32 v62, v62
    v_fma_f32 v63, v63, s57, v4
    v_exp_f32 v63, v63
    v_fma_f32 v64, v64, s57, v4
    v_exp_f32 v64, v64
    v_fma_f32 v65, v65, s57, v4
    v_exp_f32 v65, v65
    v_fma_f32 v66, v66, s57, v4
    v_exp_f32 v66, v66
    v_fma_f32 v67, v67, s57, v4
    v_exp_f32 v67, v67
    v_add_f32 v14, v14, v52
    v_add_f32 v14, v14, v53
    v_add_f32 v14, v14, v54
    v_add_f32 v14, v14, v55
    v_add_f32 v14, v14, v56
    v_add_f32 v14, v14, v57
    v_add_f32 v14, v14, v58
    v_add_f32 v14, v14, v59
    v_add_f32 v14, v14, v60
    v_add_f32 v14, v14, v61
    v_add_f32 v14, v14, v62
    v_add_f32 v14, v14, v63
    v_add_f32 v14, v14, v64
    v_add_f32 v14, v14, v65
    v_add_f32 v14, v14, v66
    v_add_f32 v14, v14, v67
    v_cvt_pk_bf16_f32 v52, v52, v53
    v_cvt_pk_bf16_f32 v53, v54, v55
    v_cvt_pk_bf16_f32 v54, v56, v57
    v_cvt_pk_bf16_f32 v55, v58, v59
    v_cvt_pk_bf16_f32 v56, v60, v61
    v_cvt_pk_bf16_f32 v57, v62, v63
    v_cvt_pk_bf16_f32 v58, v64, v65
    v_cvt_pk_bf16_f32 v59, v66, v67
    v_mov_b32 v20, v14
    s_nop 1
    v_permlane16_swap_b32 v14, v20
    v_add_f32 v14, v14, v20
    v_mov_b32 v20, v14
    s_nop 1
    v_permlane32_swap_b32 v14, v20
    v_add_f32 v14, v14, v20
    s_mov_b64 exec, 0xf
    ds_write_b32 v17, v14 offset:128
    ds_write_b32 v17, v13
    s_mov_b64 exec, 1
    v_mov_b32 v20, 1
    s_waitcnt lgkmcnt(0)
    ds_add_u32 v18, v20 offset:8
    s_mov_b64 exec, -1
    s_add_u32 s55, s55, 4096
    s_waitcnt vmcnt(15)
    s_sub_u32 s98, s98, s99
Ltp_119:
    s_memrealtime s[96:97]
    s_waitcnt lgkmcnt(0)
    s_sub_u32 s96, s96, s98
    s_cmp_ge_u32 s96, 1888
    s_cbranch_scc1 Ltd_120
    s_sleep 1
    s_branch Ltp_119
Ltd_120:
    buffer_load_dwordx4 v[148:151], v12, s[8:11], s55 offen offset:0 nt
    s_waitcnt vmcnt(15)
Ltp_121:
    s_memrealtime s[96:97]
    s_waitcnt lgkmcnt(0)
    s_sub_u32 s96, s96, s98
    s_cmp_ge_u32 s96, 1920
    s_cbranch_scc1 Ltd_122
    s_sleep 1
    s_branch Ltp_121
Ltd_122:
    buffer_load_dwordx4 v[152:155], v12, s[8:11], s55 offen offset:1024 nt
    v_mul_f32_dpp v68, v15, v68 quad_perm:[0,0,0,0] row_mask:0xf bank_mask:0xf
    v_mul_f32_dpp v69, v15, v69 quad_perm:[1,1,1,1] row_mask:0xf bank_mask:0xf
    v_mul_f32_dpp v70, v15, v70 quad_perm:[2,2,2,2] row_mask:0xf bank_mask:0xf
    v_mul_f32_dpp v71, v15, v71 quad_perm:[3,3,3,3] row_mask:0xf bank_mask:0xf
    v_mul_f32_dpp v72, v15, v72 quad_perm:[0,0,0,0] row_mask:0xf bank_mask:0xf
    v_mul_f32_dpp v73, v15, v73 quad_perm:[1,1,1,1] row_mask:0xf bank_mask:0xf
    v_mul_f32_dpp v74, v15, v74 quad_perm:[2,2,2,2] row_mask:0xf bank_mask:0xf
    v_mul_f32_dpp v75, v15, v75 quad_perm:[3,3,3,3] row_mask:0xf bank_mask:0xf
    v_mul_f32_dpp v76, v15, v76 quad_perm:[0,0,0,0] row_mask:0xf bank_mask:0xf
    v_mul_f32_dpp v77, v15, v77 quad_perm:[1,1,1,1] row_mask:0xf bank_mask:0xf
    v_mul_f32_dpp v78, v15, v78 quad_perm:[2,2,2,2] row_mask:0xf bank_mask:0xf
    v_mul_f32_dpp v79, v15, v79 quad_perm:[3,3,3,3] row_mask:0xf bank_mask:0xf
    v_mul_f32_dpp v80, v15, v80 quad_perm:[0,0,0,0] row_mask:0xf bank_mask:0xf
    v_mul_f32_dpp v81, v15, v81 quad_perm:[1,1,1,1] row_mask:0xf bank_mask:0xf
    v_mul_f32_dpp v82, v15, v82 quad_perm:[2,2,2,2] row_mask:0xf bank_mask:0xf
    v_mul_f32_dpp v83, v15, v83 quad_perm:[3,3,3,3] row_mask:0xf bank_mask:0xf
    v_mul_f32_dpp v84, v15, v84 quad_perm:[0,0,0,0] row_mask:0xf bank_mask:0xf
    v_mul_f32_dpp v85, v15, v85 quad_perm:[1,1,1,1] row_mask:0xf bank_mask:0xf
    v_mul_f32_dpp v86, v15, v86 quad_perm:[2,2,2,2] row_mask:0xf bank_mask:0xf
    v_mul_f32_dpp v87, v15, v87 quad_perm:[3,3,3,3] row_mask:0xf bank_mask:0xf
    v_mul_f32_dpp v88, v15, v88 quad_perm:[0,0,0,0] row_mask:0xf bank_mask:0xf
    v_mul_f32_dpp v89, v15, v89 quad_perm:[1,1,1,1] row_mask:0xf bank_mask:0xf
    v_mul_f32_dpp v90, v15, v90 quad_perm:[2,2,2,2] row_mask:0xf bank_mask:0xf
    v_mul_f32_dpp v91, v15, v91 quad_perm:[3,3,3,3] row_mask:0xf bank_mask:0xf
    v_mul_f32_dpp v92, v15, v92 quad_perm:[0,0,0,0] row_mask:0xf bank_mask:0xf
    v_mul_f32_dpp v93, v15, v93 quad_perm:[1,1,1,1] row_mask:0xf bank_mask:0xf
    v_mul_f32_dpp v94, v15, v94 quad_perm:[2,2,2,2] row_mask:0xf bank_mask:0xf
    v_mul_f32_dpp v95, v15, v95 quad_perm:[3,3,3,3] row_mask:0xf bank_mask:0xf
    v_mul_f32_dpp v96, v15, v96 quad_perm:[0,0,0,0] row_mask:0xf bank_mask:0xf
    v_mul_f32_dpp v97, v15, v97 quad_perm:[1,1,1,1] row_mask:0xf bank_mask:0xf
    v_mul_f32_dpp v98, v15, v98 quad_perm:[2,2,2,2] row_mask:0xf bank_mask:0xf
    v_mul_f32_dpp v99, v15, v99 quad_perm:[3,3,3,3] row_mask:0xf bank_mask:0xf
    s_waitcnt vmcnt(15)
Ltp_123:
    s_memrealtime s[96:97]
    s_waitcnt lgkmcnt(0)
    s_sub_u32 s96, s96, s98
    s_cmp_ge_u32 s96, 1952
    s_cbranch_scc1 Ltd_124
    s_sleep 1
    s_branch Ltp_123
Ltd_124:
    buffer_load_dwordx4 v[156:159], v12, s[8:11], s55 offen offset:2048 nt
    s_waitcnt vmcnt(15)
Ltp_125:
    s_memrealtime s[96:97]
    s_waitcnt lgkmcnt(0)
    s_sub_u32 s96, s96, s98
    s_cmp_ge_u32 s96, 1984
    s_cbranch_scc1 Ltd_126
    s_sleep 1
    s_branch Ltp_125
Ltd_126:
    buffer_load_dwordx4 v[160:163], v12, s[8:11], s55 offen offset:3072 nt
    s_waitcnt vmcnt(8)
    v_perm_b32 v20, v104, v100, s47
    v_perm_b32 v21, v112, v108, s47
    v_perm_b32 v22, v120, v116, s47
    v_perm_b32 v23, v128, v124, s47
    v_perm_b32 v24, v104, v100, s48
    v_perm_b32 v25, v112, v108, s48
    v_perm_b32 v26, v120, v116, s48
    v_perm_b32 v27, v128, v124, s48
    v_mfma_f32_16x16x32_bf16 v[68:71], v[52:55], v[20:23], v[68:71]
    s_nop 0
    v_mfma_f32_16x16x32_bf16 v[72:75], v[52:55], v[24:27], v[72:75]
    v_perm_b32 v28, v105, v101, s47
    v_perm_b32 v29, v113, v109, s47
    v_perm_b32 v30, v121, v117, s47
    v_perm_b32 v31, v129, v125, s47
    v_perm_b32 v32, v105, v101, s48
    v_perm_b32 v33, v113, v109, s48
    v_perm_b32 v34, v121, v117, s48
    v_perm_b32 v35, v129, v125, s48
    v_mfma_f32_16x16x32_bf16 v[76:79], v[52:55], v[28:31], v[76:79]
    s_nop 0
    v_mfma_f32_16x16x32_bf16 v[80:83], v[52:55], v[32:35], v[80:83]
    v_perm_b32 v36, v106, v102, s47
    v_perm_b32 v37, v114, v110, s47
    v_perm_b32 v38, v122, v118, s47
    v_perm_b32 v39, v130, v126, s47
    v_perm_b32 v40, v106, v102, s48
    v_perm_b32 v41, v114, v110, s48
    v_perm_b32 v42, v122, v118, s48
    v_perm_b32 v43, v130, v126, s48
    v_mfma_f32_16x16x32_bf16 v[84:87], v[52:55], v[36:39], v[84:87]
    s_nop 0
    v_mfma_f32_16x16x32_bf16 v[88:91], v[52:55], v[40:43], v[88:91]
    v_perm_b32 v44, v107, v103, s47
    v_perm_b32 v45, v115, v111, s47
    v_perm_b32 v46, v123, v119, s47
    v_perm_b32 v47, v131, v127, s47
    v_perm_b32 v48, v107, v103, s48
    v_perm_b32 v49, v115, v111, s48
    v_perm_b32 v50, v123, v119, s48
    v_perm_b32 v51, v131, v127, s48
    v_mfma_f32_16x16x32_bf16 v[92:95], v[52:55], v[44:47], v[92:95]
    s_nop 0
    v_mfma_f32_16x16x32_bf16 v[96:99], v[52:55], v[48:51], v[96:99]
    s_waitcnt vmcnt(6)
    v_perm_b32 v20, v136, v132, s47
    v_perm_b32 v24, v136, v132, s48
    v_perm_b32 v28, v137, v133, s47
    v_perm_b32 v32, v137, v133, s48
    v_perm_b32 v36, v138, v134, s47
    v_perm_b32 v40, v138, v134, s48
    v_perm_b32 v44, v139, v135, s47
    v_perm_b32 v48, v139, v135, s48
    s_waitcnt vmcnt(4)
    v_perm_b32 v21, v144, v140, s47
    v_perm_b32 v25, v144, v140, s48
    v_perm_b32 v29, v145, v141, s47
    v_perm_b32 v33, v145, v141, s48
    v_perm_b32 v37, v146, v142, s47
    v_perm_b32 v41, v146, v142, s48
    v_perm_b32 v45, v147, v143, s47
    v_perm_b32 v49, v147, v143, s48
    s_waitcnt vmcnt(2)
    v_perm_b32 v22, v152, v148, s47
    v_perm_b32 v26, v152, v148, s48
    v_perm_b32 v30, v153, v149, s47
    v_perm_b32 v34, v153, v149, s48
    v_perm_b32 v38, v154, v150, s47
    v_perm_b32 v42, v154, v150, s48
    v_perm_b32 v46, v155, v151, s47
    v_perm_b32 v50, v155, v151, s48
    s_waitcnt vmcnt(0)
    v_perm_b32 v23, v160, v156, s47
    v_perm_b32 v27, v160, v156, s48
    v_perm_b32 v31, v161, v157, s47
    v_perm_b32 v35, v161, v157, s48
    v_perm_b32 v39, v162, v158, s47
    v_perm_b32 v43, v162, v158, s48
    v_perm_b32 v47, v163, v159, s47
    v_perm_b32 v51, v163, v159, s48
    v_mfma_f32_16x16x32_bf16 v[68:71], v[56:59], v[20:23], v[68:71]
    v_mfma_f32_16x16x32_bf16 v[72:75], v[56:59], v[24:27], v[72:75]
    v_mfma_f32_16x16x32_bf16 v[76:79], v[56:59], v[28:31], v[76:79]
    v_mfma_f32_16x16x32_bf16 v[80:83], v[56:59], v[32:35], v[80:83]
    v_mfma_f32_16x16x32_bf16 v[84:87], v[56:59], v[36:39], v[84:87]
    v_mfma_f32_16x16x32_bf16 v[88:91], v[56:59], v[40:43], v[88:91]
    v_mfma_f32_16x16x32_bf16 v[92:95], v[56:59], v[44:47], v[92:95]
    v_mfma_f32_16x16x32_bf16 v[96:99], v[56:59], v[48:51], v[96:99]
    v_lshlrev_b32 v16, 4, v3
    v_add_u32 v16, s56, v16
    s_mov_b64 exec, 0xffff
    ds_write_b128 v16, v[68:71] offset:0
    ds_write_b128 v16, v[72:75] offset:256
    ds_write_b128 v16, v[76:79] offset:512
    ds_write_b128 v16, v[80:83] offset:768
    ds_write_b128 v16, v[84:87] offset:1024
    ds_write_b128 v16, v[88:91] offset:1280
    ds_write_b128 v16, v[92:95] offset:1536
    ds_write_b128 v16, v[96:99] offset:1792
    s_mov_b64 exec, 1
    v_mov_b32 v20, 1
    s_waitcnt lgkmcnt(0)
    ds_add_u32 v18, v20 offset:12
    s_mov_b64 exec, -1
    s_cmp_ge_u32 s3, 2
    s_cbranch_scc1 L_notcomb
    s_mov_b32 s49, 0
Lspin_127:
    ds_read_b32 v20, v18 offset:20
    s_waitcnt lgkmcnt(0)
    v_readfirstlane_b32 s50, v20
    s_nop 0
    s_cmp_eq_u32 s50, 1
    s_cbranch_scc1 Lspun_128
    s_add_u32 s49, s49, 1
    s_cmp_lt_u32 s49, 4194304
    s_cbranch_scc1 Lspin_127
Lspun_128:
    v_mov_b32 v17, 132608
    ds_read_b128 v[132:135], v17 offset:0
    ds_read_b128 v[136:139], v17 offset:16
    ds_read_b128 v[140:143], v17 offset:32
    ds_read_b128 v[144:147], v17 offset:48
    ds_read_b128 v[148:151], v17 offset:64
    ds_read_b128 v[152:155], v17 offset:80
    ds_read_b128 v[156:159], v17 offset:96
    ds_read_b128 v[160:163], v17 offset:112
    s_lshl_b32 s57, s3, 6
    v_add_u32 v16, s57, v1
    v_and_b32 v17, 7, v16
    v_lshlrev_b32 v17, 8, v17
    v_lshrrev_b32 v15, 3, v16
    v_lshl_add_u32 v17, v15, 4, v17
    v_add_u32 v15, 0x10000, v17
    s_mov_b32 s49, 0
Lspin_129:
    ds_read_b32 v20, v18 offset:12
    s_waitcnt lgkmcnt(0)
    v_readfirstlane_b32 s50, v20
    s_nop 0
    s_cmp_eq_u32 s50, 8
    s_cbranch_scc1 Lspun_130
    s_add_u32 s49, s49, 1
    s_cmp_lt_u32 s49, 4194304
    s_cbranch_scc1 Lspin_129
Lspun_130:
    ds_read_b128 v[100:103], v17 offset:0
    ds_read_b128 v[104:107], v17 offset:16384
    ds_read_b128 v[108:111], v17 offset:32768
    ds_read_b128 v[112:115], v17 offset:49152
    ds_read_b128 v[116:119], v15 offset:0
    ds_read_b128 v[120:123], v15 offset:16384
    ds_read_b128 v[124:127], v15 offset:32768
    ds_read_b128 v[128:131], v15 offset:49152
    s_waitcnt lgkmcnt(7)
    v_mul_f32 v100, v100, v132
    v_mul_f32 v101, v101, v133
    v_mul_f32 v102, v102, v134
    v_mul_f32 v103, v103, v135
    s_waitcnt lgkmcnt(6)
    v_mul_f32 v104, v104, v136
    v_mul_f32 v105, v105, v137
    v_mul_f32 v106, v106, v138
    v_mul_f32 v107, v107, v139
    s_waitcnt lgkmcnt(5)
    v_fmac_f32 v100, v108, v140
    v_fmac_f32 v101, v109, v141
    v_fmac_f32 v102, v110, v142
    v_fmac_f32 v103, v111, v143
    s_waitcnt lgkmcnt(4)
    v_fmac_f32 v104, v112, v144
    v_fmac_f32 v105, v113, v145
    v_fmac_f32 v106, v114, v146
    v_fmac_f32 v107, v115, v147
    s_waitcnt lgkmcnt(3)
    v_fmac_f32 v100, v116, v148
    v_fmac_f32 v101, v117, v149
    v_fmac_f32 v102, v118, v150
    v_fmac_f32 v103, v119, v151
    s_waitcnt lgkmcnt(2)
    v_fmac_f32 v104, v120, v152
    v_fmac_f32 v105, v121, v153
    v_fmac_f32 v106, v122, v154
    v_fmac_f32 v107, v123, v155
    s_waitcnt lgkmcnt(1)
    v_fmac_f32 v100, v124, v156
    v_fmac_f32 v101, v125, v157
    v_fmac_f32 v102, v126, v158
    v_fmac_f32 v103, v127, v159
    s_waitcnt lgkmcnt(0)
    v_fmac_f32 v104, v128, v160
    v_fmac_f32 v105, v129, v161
    v_fmac_f32 v106, v130, v162
    v_fmac_f32 v107, v131, v163
    v_add_f32 v100, v100, v104
    v_add_f32 v101, v101, v105
    v_add_f32 v102, v102, v106
    v_add_f32 v103, v103, v107
    v_add_u32 v100, 0x200, v100
    v_and_b32 v100, 0xfffffc00, v100
    v_or_b32 v100, s90, v100
    v_add_u32 v101, 0x200, v101
    v_and_b32 v101, 0xfffffc00, v101
    v_or_b32 v101, s91, v101
    v_add_u32 v102, 0x200, v102
    v_and_b32 v102, 0xfffffc00, v102
    v_or_b32 v102, s92, v102
    v_add_u32 v103, 0x200, v103
    v_and_b32 v103, 0xfffffc00, v103
    v_or_b32 v103, s93, v103
    s_lshl_b32 s57, s45, 3
    s_add_u32 s57, s57, s44
    s_lshl_b32 s57, s57, 2
    s_add_u32 s57, s57, s46
    s_lshl_b32 s57, s57, 11
    s_add_u32 s57, s57, 135266304
    v_lshlrev_b32 v16, 4, v16
    buffer_store_dwordx4 v[100:103], v16, s[12:15], s57 offen sc1
    s_branch L_b2
L_notcomb:
    s_cmp_ge_u32 s3, 6
    s_cbranch_scc1 L_b2
    s_sub_u32 s57, s3, 2
    s_lshl_b32 s57, s57, 1
    v_lshrrev_b32 v16, 5, v1
    v_add_u32 v16, s57, v16
    v_and_b32 v17, 31, v1
    v_lshlrev_b32 v15, 16, v16
    v_lshl_add_u32 v15, v17, 4, v15
    s_lshl_b32 s52, s94, 13
    s_lshl_b32 s53, s95, 9
    s_add_u32 s52, s52, s53
    s_add_u32 s52, s52, 135266304
    s_add_u32 s53, s52, 4096
    s_lshl_b32 s54, s94, 15
    s_lshr_b32 s50, s2, 3
    s_lshl_b32 s50, s50, 10
    s_add_u32 s54, s54, s50
    s_lshl_b32 s50, s57, 7
    s_add_u32 s54, s54, s50
    s_add_u32 s54, s54, 136314880
    v_lshlrev_b32 v21, 4, v1
    v_add_u32 v22, s56, v21
    v_lshrrev_b32 v23, 5, v1
    v_lshlrev_b32 v23, 7, v23
    v_add_u32 v23, s56, v23
    s_mov_b64 s[64:65], 0xffff
    s_mov_b64 exec, s[64:65]
    s_cbranch_execz Lpk_131
    buffer_load_dwordx4 v[52:55], v21, s[12:15], s54 offen sc1
Lpk_131:
    s_mov_b64 exec, -1
    s_sleep 24
    buffer_load_dwordx4 v[100:103], v15, s[12:15], s52 offen offset:0 sc1
    buffer_load_dwordx4 v[104:107], v15, s[12:15], s52 offen offset:2048 sc1
    buffer_load_dwordx4 v[108:111], v15, s[12:15], s53 offen offset:0 sc1
    buffer_load_dwordx4 v[112:115], v15, s[12:15], s53 offen offset:2048 sc1
    s_waitcnt vmcnt(4)
    s_mov_b64 exec, s[64:65]
    s_cbranch_execz Lpc_132
    v_xor_b32 v52, s90, v52
    v_xor_b32 v53, s91, v53
    v_xor_b32 v54, s92, v54
    v_xor_b32 v55, s93, v55
    v_or3_b32 v20, v52, v53, v54
    v_or_b32 v20, v20, v55
    v_and_b32 v20, 0x3ff, v20
    v_cmp_ne_u32 s[64:65], 0, v20
Lpc_132:
    s_mov_b64 exec, -1
    s_or_b64 vcc, s[64:65], s[64:65]
    s_waitcnt vmcnt(0)
    v_xor_b32 v100, s90, v100
    v_xor_b32 v101, s91, v101
    v_xor_b32 v102, s92, v102
    v_xor_b32 v103, s93, v103
    v_or3_b32 v20, v100, v101, v102
    v_or_b32 v20, v20, v103
    v_and_b32 v20, 0x3ff, v20
    v_cmp_ne_u32 s[80:81], 0, v20
    v_xor_b32 v104, s90, v104
    v_xor_b32 v105, s91, v105
    v_xor_b32 v106, s92, v106
    v_xor_b32 v107, s93, v107
    v_or3_b32 v20, v104, v105, v106
    v_or_b32 v20, v20, v107
    v_and_b32 v20, 0x3ff, v20
    v_cmp_ne_u32 s[82:83], 0, v20
    v_xor_b32 v108, s90, v108
    v_xor_b32 v109, s91, v109
    v_xor_b32 v110, s92, v110
    v_xor_b32 v111, s93, v111
    v_or3_b32 v20, v108, v109, v110
    v_or_b32 v20, v20, v111
    v_and_b32 v20, 0x3ff, v20
    v_cmp_ne_u32 s[84:85], 0, v20
    v_xor_b32 v112, s90, v112
    v_xor_b32 v113, s91, v113
    v_xor_b32 v114, s92, v114
    v_xor_b32 v115, s93, v115
    v_or3_b32 v20, v112, v113, v114
    v_or_b32 v20, v20, v115
    v_and_b32 v20, 0x3ff, v20
    v_cmp_ne_u32 s[86:87], 0, v20
    s_nop 0
    s_or_b64 vcc, s[80:81], s[86:87]
    s_or_b64 vcc, vcc, s[82:83]
    s_or_b64 vcc, vcc, s[84:85]
    s_or_b64 vcc, s[64:65], s[64:65]
    s_cbranch_scc0 Lpolled_134
    s_mov_b32 s49, 0
Lpoll_133:
    s_sleep 2
    s_mov_b64 exec, s[64:65]
    s_cbranch_execz Lpk_135
    buffer_load_dwordx4 v[52:55], v21, s[12:15], s54 offen sc1
Lpk_135:
    s_mov_b64 exec, -1
    s_waitcnt vmcnt(0)
    s_mov_b64 exec, s[64:65]
    s_cbranch_execz Lpc_136
    v_xor_b32 v52, s90, v52
    v_xor_b32 v53, s91, v53
    v_xor_b32 v54, s92, v54
    v_xor_b32 v55, s93, v55
    v_or3_b32 v20, v52, v53, v54
    v_or_b32 v20, v20, v55
    v_and_b32 v20, 0x3ff, v20
    v_cmp_ne_u32 s[64:65], 0, v20
Lpc_136:
    s_mov_b64 exec, -1
    s_or_b64 vcc, s[64:65], s[64:65]
    s_cbranch_scc0 Lpolled_134
    s_add_u32 s49, s49, 1
    s_cmp_lt_u32 s49, 4194304
    s_cbranch_scc1 Lpoll_133
Lpolled_134:
    s_nop 1
    s_mov_b64 exec, s[80:81]
    s_cbranch_execz Lpk_137
    buffer_load_dwordx4 v[100:103], v15, s[12:15], s52 offen offset:0 sc1
Lpk_137:
    s_mov_b64 exec, s[82:83]
    s_cbranch_execz Lpk_138
    buffer_load_dwordx4 v[104:107], v15, s[12:15], s52 offen offset:2048 sc1
Lpk_138:
    s_mov_b64 exec, s[84:85]
    s_cbranch_execz Lpk_139
    buffer_load_dwordx4 v[108:111], v15, s[12:15], s53 offen offset:0 sc1
Lpk_139:
    s_mov_b64 exec, s[86:87]
    s_cbranch_execz Lpk_140
    buffer_load_dwordx4 v[112:115], v15, s[12:15], s53 offen offset:2048 sc1
Lpk_140:
    s_mov_b64 exec, -1
    s_mov_b64 exec, 0xffff
    ds_write_b128 v22, v[52:55] offset:4096
    s_mov_b64 exec, -1
    ds_read_b128 v[132:135], v23 offset:4096
    ds_read_b128 v[136:139], v23 offset:4112
    ds_read_b128 v[140:143], v23 offset:4128
    ds_read_b128 v[144:147], v23 offset:4144
    ds_read_b128 v[148:151], v23 offset:4160
    ds_read_b128 v[152:155], v23 offset:4176
    ds_read_b128 v[156:159], v23 offset:4192
    ds_read_b128 v[160:163], v23 offset:4208
    s_waitcnt lgkmcnt(0)
    s_mov_b32 s57, 0x3fb8aa3b
    v_max3_f32 v24, v132, v140, v148
    v_max3_f32 v25, v133, v141, v149
    v_max3_f32 v26, v134, v142, v150
    v_max3_f32 v27, v135, v143, v151
    v_max_f32 v24, v24, v156
    v_max_f32 v25, v25, v157
    v_max_f32 v26, v26, v158
    v_max_f32 v27, v27, v159
    v_mul_f32 v24, 0xbfb8aa3b, v24
    v_mul_f32 v25, 0xbfb8aa3b, v25
    v_mul_f32 v26, 0xbfb8aa3b, v26
    v_mul_f32 v27, 0xbfb8aa3b, v27
    v_fma_f32 v132, v132, s57, v24
    v_fma_f32 v133, v133, s57, v25
    v_fma_f32 v134, v134, s57, v26
    v_fma_f32 v135, v135, s57, v27
    v_fma_f32 v140, v140, s57, v24
    v_fma_f32 v141, v141, s57, v25
    v_fma_f32 v142, v142, s57, v26
    v_fma_f32 v143, v143, s57, v27
    v_fma_f32 v148, v148, s57, v24
    v_fma_f32 v149, v149, s57, v25
    v_fma_f32 v150, v150, s57, v26
    v_fma_f32 v151, v151, s57, v27
    v_fma_f32 v156, v156, s57, v24
    v_fma_f32 v157, v157, s57, v25
    v_fma_f32 v158, v158, s57, v26
    v_fma_f32 v159, v159, s57, v27
    v_exp_f32 v132, v132
    v_exp_f32 v133, v133
    v_exp_f32 v134, v134
    v_exp_f32 v135, v135
    v_exp_f32 v140, v140
    v_exp_f32 v141, v141
    v_exp_f32 v142, v142
    v_exp_f32 v143, v143
    v_exp_f32 v148, v148
    v_exp_f32 v149, v149
    v_exp_f32 v150, v150
    v_exp_f32 v151, v151
    v_exp_f32 v156, v156
    v_exp_f32 v157, v157
    v_exp_f32 v158, v158
    v_exp_f32 v159, v159
    v_mul_f32 v24, v132, v136
    v_mul_f32 v25, v133, v137
    v_mul_f32 v26, v134, v138
    v_mul_f32 v27, v135, v139
    v_fmac_f32 v24, v140, v144
    v_fmac_f32 v25, v141, v145
    v_fmac_f32 v26, v142, v146
    v_fmac_f32 v27, v143, v147
    v_fmac_f32 v24, v148, v152
    v_fmac_f32 v25, v149, v153
    v_fmac_f32 v26, v150, v154
    v_fmac_f32 v27, v151, v155
    v_fmac_f32 v24, v156, v160
    v_fmac_f32 v25, v157, v161
    v_fmac_f32 v26, v158, v162
    v_fmac_f32 v27, v159, v163
    v_rcp_f32 v24, v24
    v_rcp_f32 v25, v25
    v_rcp_f32 v26, v26
    v_rcp_f32 v27, v27
    v_mul_f32 v132, v132, v24
    v_mul_f32 v133, v133, v25
    v_mul_f32 v134, v134, v26
    v_mul_f32 v135, v135, v27
    v_mul_f32 v140, v140, v24
    v_mul_f32 v141, v141, v25
    v_mul_f32 v142, v142, v26
    v_mul_f32 v143, v143, v27
    v_mul_f32 v148, v148, v24
    v_mul_f32 v149, v149, v25
    v_mul_f32 v150, v150, v26
    v_mul_f32 v151, v151, v27
    v_mul_f32 v156, v156, v24
    v_mul_f32 v157, v157, v25
    v_mul_f32 v158, v158, v26
    v_mul_f32 v159, v159, v27
    s_waitcnt vmcnt(0)
    s_mov_b64 exec, s[80:81]
    s_cbranch_execz Lpc_141
    v_xor_b32 v100, s90, v100
    v_xor_b32 v101, s91, v101
    v_xor_b32 v102, s92, v102
    v_xor_b32 v103, s93, v103
    v_or3_b32 v20, v100, v101, v102
    v_or_b32 v20, v20, v103
    v_and_b32 v20, 0x3ff, v20
    v_cmp_ne_u32 s[80:81], 0, v20
Lpc_141:
    s_mov_b64 exec, s[82:83]
    s_cbranch_execz Lpc_142
    v_xor_b32 v104, s90, v104
    v_xor_b32 v105, s91, v105
    v_xor_b32 v106, s92, v106
    v_xor_b32 v107, s93, v107
    v_or3_b32 v20, v104, v105, v106
    v_or_b32 v20, v20, v107
    v_and_b32 v20, 0x3ff, v20
    v_cmp_ne_u32 s[82:83], 0, v20
Lpc_142:
    s_mov_b64 exec, s[84:85]
    s_cbranch_execz Lpc_143
    v_xor_b32 v108, s90, v108
    v_xor_b32 v109, s91, v109
    v_xor_b32 v110, s92, v110
    v_xor_b32 v111, s93, v111
    v_or3_b32 v20, v108, v109, v110
    v_or_b32 v20, v20, v111
    v_and_b32 v20, 0x3ff, v20
    v_cmp_ne_u32 s[84:85], 0, v20
Lpc_143:
    s_mov_b64 exec, s[86:87]
    s_cbranch_execz Lpc_144
    v_xor_b32 v112, s90, v112
    v_xor_b32 v113, s91, v113
    v_xor_b32 v114, s92, v114
    v_xor_b32 v115, s93, v115
    v_or3_b32 v20, v112, v113, v114
    v_or_b32 v20, v20, v115
    v_and_b32 v20, 0x3ff, v20
    v_cmp_ne_u32 s[86:87], 0, v20
Lpc_144:
    s_mov_b64 exec, -1
    s_or_b64 vcc, s[80:81], s[86:87]
    s_or_b64 vcc, vcc, s[82:83]
    s_or_b64 vcc, vcc, s[84:85]
    s_cbranch_scc0 Lpolled_146
    s_mov_b32 s49, 0
Lpoll_145:
    s_sleep 1
    s_mov_b64 exec, s[80:81]
    s_cbranch_execz Lpk_147
    buffer_load_dwordx4 v[100:103], v15, s[12:15], s52 offen offset:0 sc1
Lpk_147:
    s_mov_b64 exec, s[82:83]
    s_cbranch_execz Lpk_148
    buffer_load_dwordx4 v[104:107], v15, s[12:15], s52 offen offset:2048 sc1
Lpk_148:
    s_mov_b64 exec, s[84:85]
    s_cbranch_execz Lpk_149
    buffer_load_dwordx4 v[108:111], v15, s[12:15], s53 offen offset:0 sc1
Lpk_149:
    s_mov_b64 exec, s[86:87]
    s_cbranch_execz Lpk_150
    buffer_load_dwordx4 v[112:115], v15, s[12:15], s53 offen offset:2048 sc1
Lpk_150:
    s_mov_b64 exec, -1
    s_waitcnt vmcnt(0)
    s_mov_b64 exec, s[80:81]
    s_cbranch_execz Lpc_151
    v_xor_b32 v100, s90, v100
    v_xor_b32 v101, s91, v101
    v_xor_b32 v102, s92, v102
    v_xor_b32 v103, s93, v103
    v_or3_b32 v20, v100, v101, v102
    v_or_b32 v20, v20, v103
    v_and_b32 v20, 0x3ff, v20
    v_cmp_ne_u32 s[80:81], 0, v20
Lpc_151:
    s_mov_b64 exec, s[82:83]
    s_cbranch_execz Lpc_152
    v_xor_b32 v104, s90, v104
    v_xor_b32 v105, s91, v105
    v_xor_b32 v106, s92, v106
    v_xor_b32 v107, s93, v107
    v_or3_b32 v20, v104, v105, v106
    v_or_b32 v20, v20, v107
    v_and_b32 v20, 0x3ff, v20
    v_cmp_ne_u32 s[82:83], 0, v20
Lpc_152:
    s_mov_b64 exec, s[84:85]
    s_cbranch_execz Lpc_153
    v_xor_b32 v108, s90, v108
    v_xor_b32 v109, s91, v109
    v_xor_b32 v110, s92, v110
    v_xor_b32 v111, s93, v111
    v_or3_b32 v20, v108, v109, v110
    v_or_b32 v20, v20, v111
    v_and_b32 v20, 0x3ff, v20
    v_cmp_ne_u32 s[84:85], 0, v20
Lpc_153:
    s_mov_b64 exec, s[86:87]
    s_cbranch_execz Lpc_154
    v_xor_b32 v112, s90, v112
    v_xor_b32 v113, s91, v113
    v_xor_b32 v114, s92, v114
    v_xor_b32 v115, s93, v115
    v_or3_b32 v20, v112, v113, v114
    v_or_b32 v20, v20, v115
    v_and_b32 v20, 0x3ff, v20
    v_cmp_ne_u32 s[86:87], 0, v20
Lpc_154:
    s_mov_b64 exec, -1
    s_or_b64 vcc, s[80:81], s[86:87]
    s_or_b64 vcc, vcc, s[82:83]
    s_or_b64 vcc, vcc, s[84:85]
    s_cbranch_scc0 Lpolled_146
    s_add_u32 s49, s49, 1
    s_cmp_lt_u32 s49, 4194304
    s_cbranch_scc1 Lpoll_145
Lpolled_146:
    s_nop 1
    v_mul_f32 v100, v100, v132
    v_mul_f32 v108, v108, v148
    v_mul_f32 v101, v101, v133
    v_mul_f32 v109, v109, v149
    v_mul_f32 v102, v102, v134
    v_mul_f32 v110, v110, v150
    v_mul_f32 v103, v103, v135
    v_mul_f32 v111, v111, v151
    v_fmac_f32 v100, v104, v140
    v_fmac_f32 v108, v112, v156
    v_fmac_f32 v101, v105, v141
    v_fmac_f32 v109, v113, v157
    v_fmac_f32 v102, v106, v142
    v_fmac_f32 v110, v114, v158
    v_fmac_f32 v103, v107, v143
    v_fmac_f32 v111, v115, v159
    v_add_f32 v100, v100, v108
    v_add_f32 v101, v101, v109
    v_add_f32 v102, v102, v110
    v_add_f32 v103, v103, v111
    v_cvt_pk_bf16_f32 v20, v100, v101
    v_cvt_pk_bf16_f32 v21, v102, v103
    v_lshlrev_b32 v16, 8, v16
    v_lshl_add_u32 v16, v17, 3, v16
    v_add_u32 v16, 133120, v16
    ds_write_b64 v16, v[20:21]
    s_mov_b64 exec, 1
    v_mov_b32 v22, 1
    s_waitcnt lgkmcnt(0)
    ds_add_u32 v18, v22 offset:16
    s_mov_b64 exec, -1
L_b2:
    s_cmp_ge_u32 s2, 8
    s_cbranch_scc1 L_end
    v_lshlrev_b32 v12, 1, v0
    s_lshl_b32 s57, s2, 10
    buffer_load_ushort v164, v12, s[16:19], s57 offen
    buffer_load_ushort v165, v12, s[28:31], s57 offen
    s_add_u32 s52, s3, 2
    s_and_b32 s52, s52, 7
    s_cmp_ge_u32 s52, 4
    s_cbranch_scc1 L_tb_skip
    s_load_dword s55, s[42:43], 0
    v_lshlrev_b32 v16, 4, v1
    s_lshl_b32 s53, s52, 13
    s_add_u32 s53, s53, 137363456
    s_add_u32 s54, s53, 4096
    buffer_load_dwordx4 v[100:103], v16, s[12:15], s53 offen offset:0 sc1
    buffer_load_dwordx4 v[104:107], v16, s[12:15], s53 offen offset:1024 sc1
    buffer_load_dwordx4 v[108:111], v16, s[12:15], s53 offen offset:2048 sc1
    buffer_load_dwordx4 v[112:115], v16, s[12:15], s53 offen offset:3072 sc1
    buffer_load_dwordx4 v[116:119], v16, s[12:15], s54 offen offset:0 sc1
    buffer_load_dwordx4 v[120:123], v16, s[12:15], s54 offen offset:1024 sc1
    buffer_load_dwordx4 v[124:127], v16, s[12:15], s54 offen offset:2048 sc1
    buffer_load_dwordx4 v[128:131], v16, s[12:15], s54 offen offset:3072 sc1
    s_waitcnt vmcnt(0)
    v_xor_b32 v100, s90, v100
    v_xor_b32 v101, s91, v101
    v_xor_b32 v102, s92, v102
    v_xor_b32 v103, s93, v103
    v_or3_b32 v20, v100, v101, v102
    v_or_b32 v20, v20, v103
    v_and_b32 v20, 0x3ff, v20
    v_cmp_ne_u32 s[64:65], 0, v20
    v_xor_b32 v104, s90, v104
    v_xor_b32 v105, s91, v105
    v_xor_b32 v106, s92, v106
    v_xor_b32 v107, s93, v107
    v_or3_b32 v20, v104, v105, v106
    v_or_b32 v20, v20, v107
    v_and_b32 v20, 0x3ff, v20
    v_cmp_ne_u32 s[66:67], 0, v20
    v_xor_b32 v108, s90, v108
    v_xor_b32 v109, s91, v109
    v_xor_b32 v110, s92, v110
    v_xor_b32 v111, s93, v111
    v_or3_b32 v20, v108, v109, v110
    v_or_b32 v20, v20, v111
    v_and_b32 v20, 0x3ff, v20
    v_cmp_ne_u32 s[68:69], 0, v20
    v_xor_b32 v112, s90, v112
    v_xor_b32 v113, s91, v113
    v_xor_b32 v114, s92, v114
    v_xor_b32 v115, s93, v115
    v_or3_b32 v20, v112, v113, v114
    v_or_b32 v20, v20, v115
    v_and_b32 v20, 0x3ff, v20
    v_cmp_ne_u32 s[70:71], 0, v20
    v_xor_b32 v116, s90, v116
    v_xor_b32 v117, s91, v117
    v_xor_b32 v118, s92, v118
    v_xor_b32 v119, s93, v119
    v_or3_b32 v20, v116, v117, v118
    v_or_b32 v20, v20, v119
    v_and_b32 v20, 0x3ff, v20
    v_cmp_ne_u32 s[72:73], 0, v20
    v_xor_b32 v120, s90, v120
    v_xor_b32 v121, s91, v121
    v_xor_b32 v122, s92, v122
    v_xor_b32 v123, s93, v123
    v_or3_b32 v20, v120, v121, v122
    v_or_b32 v20, v20, v123
    v_and_b32 v20, 0x3ff, v20
    v_cmp_ne_u32 s[74:75], 0, v20
    v_xor_b32 v124, s90, v124
    v_xor_b32 v125, s91, v125
    v_xor_b32 v126, s92, v126
    v_xor_b32 v127, s93, v127
    v_or3_b32 v20, v124, v125, v126
    v_or_b32 v20, v20, v127
    v_and_b32 v20, 0x3ff, v20
    v_cmp_ne_u32 s[76:77], 0, v20
    v_xor_b32 v128, s90, v128
    v_xor_b32 v129, s91, v129
    v_xor_b32 v130, s92, v130
    v_xor_b32 v131, s93, v131
    v_or3_b32 v20, v128, v129, v130
    v_or_b32 v20, v20, v131
    v_and_b32 v20, 0x3ff, v20
    v_cmp_ne_u32 s[78:79], 0, v20
    s_nop 0
    s_or_b64 vcc, s[64:65], s[78:79]
    s_or_b64 vcc, vcc, s[66:67]
    s_or_b64 vcc, vcc, s[68:69]
    s_or_b64 vcc, vcc, s[70:71]
    s_or_b64 vcc, vcc, s[72:73]
    s_or_b64 vcc, vcc, s[74:75]
    s_or_b64 vcc, vcc, s[76:77]
    s_cbranch_scc0 Lpolled_156
    s_mov_b32 s49, 0
Lpoll_155:
    s_sleep 8
    s_mov_b64 exec, s[64:65]
    s_cbranch_execz Lpk_157
    buffer_load_dwordx4 v[100:103], v16, s[12:15], s53 offen offset:0 sc1
Lpk_157:
    s_mov_b64 exec, s[66:67]
    s_cbranch_execz Lpk_158
    buffer_load_dwordx4 v[104:107], v16, s[12:15], s53 offen offset:1024 sc1
Lpk_158:
    s_mov_b64 exec, s[68:69]
    s_cbranch_execz Lpk_159
    buffer_load_dwordx4 v[108:111], v16, s[12:15], s53 offen offset:2048 sc1
Lpk_159:
    s_mov_b64 exec, s[70:71]
    s_cbranch_execz Lpk_160
    buffer_load_dwordx4 v[112:115], v16, s[12:15], s53 offen offset:3072 sc1
Lpk_160:
    s_mov_b64 exec, s[72:73]
    s_cbranch_execz Lpk_161
    buffer_load_dwordx4 v[116:119], v16, s[12:15], s54 offen offset:0 sc1
Lpk_161:
    s_mov_b64 exec, s[74:75]
    s_cbranch_execz Lpk_162
    buffer_load_dwordx4 v[120:123], v16, s[12:15], s54 offen offset:1024 sc1
Lpk_162:
    s_mov_b64 exec, s[76:77]
    s_cbranch_execz Lpk_163
    buffer_load_dwordx4 v[124:127], v16, s[12:15], s54 offen offset:2048 sc1
Lpk_163:
    s_mov_b64 exec, s[78:79]
    s_cbranch_execz Lpk_164
    buffer_load_dwordx4 v[128:131], v16, s[12:15], s54 offen offset:3072 sc1
Lpk_164:
    s_mov_b64 exec, -1
    s_waitcnt vmcnt(0)
    s_mov_b64 exec, s[64:65]
    s_cbranch_execz Lpc_165
    v_xor_b32 v100, s90, v100
    v_xor_b32 v101, s91, v101
    v_xor_b32 v102, s92, v102
    v_xor_b32 v103, s93, v103
    v_or3_b32 v20, v100, v101, v102
    v_or_b32 v20, v20, v103
    v_and_b32 v20, 0x3ff, v20
    v_cmp_ne_u32 s[64:65], 0, v20
Lpc_165:
    s_mov_b64 exec, s[66:67]
    s_cbranch_execz Lpc_166
    v_xor_b32 v104, s90, v104
    v_xor_b32 v105, s91, v105
    v_xor_b32 v106, s92, v106
    v_xor_b32 v107, s93, v107
    v_or3_b32 v20, v104, v105, v106
    v_or_b32 v20, v20, v107
    v_and_b32 v20, 0x3ff, v20
    v_cmp_ne_u32 s[66:67], 0, v20
Lpc_166:
    s_mov_b64 exec, s[68:69]
    s_cbranch_execz Lpc_167
    v_xor_b32 v108, s90, v108
    v_xor_b32 v109, s91, v109
    v_xor_b32 v110, s92, v110
    v_xor_b32 v111, s93, v111
    v_or3_b32 v20, v108, v109, v110
    v_or_b32 v20, v20, v111
    v_and_b32 v20, 0x3ff, v20
    v_cmp_ne_u32 s[68:69], 0, v20
Lpc_167:
    s_mov_b64 exec, s[70:71]
    s_cbranch_execz Lpc_168
    v_xor_b32 v112, s90, v112
    v_xor_b32 v113, s91, v113
    v_xor_b32 v114, s92, v114
    v_xor_b32 v115, s93, v115
    v_or3_b32 v20, v112, v113, v114
    v_or_b32 v20, v20, v115
    v_and_b32 v20, 0x3ff, v20
    v_cmp_ne_u32 s[70:71], 0, v20
Lpc_168:
    s_mov_b64 exec, s[72:73]
    s_cbranch_execz Lpc_169
    v_xor_b32 v116, s90, v116
    v_xor_b32 v117, s91, v117
    v_xor_b32 v118, s92, v118
    v_xor_b32 v119, s93, v119
    v_or3_b32 v20, v116, v117, v118
    v_or_b32 v20, v20, v119
    v_and_b32 v20, 0x3ff, v20
    v_cmp_ne_u32 s[72:73], 0, v20
Lpc_169:
    s_mov_b64 exec, s[74:75]
    s_cbranch_execz Lpc_170
    v_xor_b32 v120, s90, v120
    v_xor_b32 v121, s91, v121
    v_xor_b32 v122, s92, v122
    v_xor_b32 v123, s93, v123
    v_or3_b32 v20, v120, v121, v122
    v_or_b32 v20, v20, v123
    v_and_b32 v20, 0x3ff, v20
    v_cmp_ne_u32 s[74:75], 0, v20
Lpc_170:
    s_mov_b64 exec, s[76:77]
    s_cbranch_execz Lpc_171
    v_xor_b32 v124, s90, v124
    v_xor_b32 v125, s91, v125
    v_xor_b32 v126, s92, v126
    v_xor_b32 v127, s93, v127
    v_or3_b32 v20, v124, v125, v126
    v_or_b32 v20, v20, v127
    v_and_b32 v20, 0x3ff, v20
    v_cmp_ne_u32 s[76:77], 0, v20
Lpc_171:
    s_mov_b64 exec, s[78:79]
    s_cbranch_execz Lpc_172
    v_xor_b32 v128, s90, v128
    v_xor_b32 v129, s91, v129
    v_xor_b32 v130, s92, v130
    v_xor_b32 v131, s93, v131
    v_or3_b32 v20, v128, v129, v130
    v_or_b32 v20, v20, v131
    v_and_b32 v20, 0x3ff, v20
    v_cmp_ne_u32 s[78:79], 0, v20
Lpc_172:
    s_mov_b64 exec, -1
    s_or_b64 vcc, s[64:65], s[78:79]
    s_or_b64 vcc, vcc, s[66:67]
    s_or_b64 vcc, vcc, s[68:69]
    s_or_b64 vcc, vcc, s[70:71]
    s_or_b64 vcc, vcc, s[72:73]
    s_or_b64 vcc, vcc, s[74:75]
    s_or_b64 vcc, vcc, s[76:77]
    s_cbranch_scc0 Lpolled_156
    s_add_u32 s49, s49, 1
    s_cmp_lt_u32 s49, 4194304
    s_cbranch_scc1 Lpoll_155
Lpolled_156:
    s_nop 1
    s_mov_b32 s49, 0
Lspin_173:
    ds_read_b32 v20, v18 offset:48
    s_waitcnt lgkmcnt(0)
    v_readfirstlane_b32 s50, v20
    s_nop 0
    s_cmp_eq_u32 s50, 4
    s_cbranch_scc1 Lspun_174
    s_sleep 1
    s_add_u32 s49, s49, 1
    s_cmp_lt_u32 s49, 4194304
    s_cbranch_scc1 Lspin_173
Lspun_174:
    s_lshl_b32 s55, s55, 16
    s_lshl_b32 s52, s52, 12
    s_add_u32 s52, s52, 147456
    v_lshl_add_u32 v16, v1, 3, s52
    v_cvt_pk_bf16_f32 v20, v100, v101
    v_lshlrev_b32 v100, 16, v20
    v_and_b32 v101, 0xffff0000, v20
    v_add_f32 v100, s55, v100
    v_add_f32 v101, s55, v101
    v_cvt_pk_bf16_f32 v132, v100, v101
    v_cvt_pk_bf16_f32 v20, v102, v103
    v_lshlrev_b32 v102, 16, v20
    v_and_b32 v103, 0xffff0000, v20
    v_add_f32 v102, s55, v102
    v_add_f32 v103, s55, v103
    v_cvt_pk_bf16_f32 v133, v102, v103
    ds_write_b64 v16, v[132:133] offset:0
    v_cvt_pk_bf16_f32 v20, v104, v105
    v_lshlrev_b32 v104, 16, v20
    v_and_b32 v105, 0xffff0000, v20
    v_add_f32 v104, s55, v104
    v_add_f32 v105, s55, v105
    v_cvt_pk_bf16_f32 v134, v104, v105
    v_cvt_pk_bf16_f32 v20, v106, v107
    v_lshlrev_b32 v106, 16, v20
    v_and_b32 v107, 0xffff0000, v20
    v_add_f32 v106, s55, v106
    v_add_f32 v107, s55, v107
    v_cvt_pk_bf16_f32 v135, v106, v107
    ds_write_b64 v16, v[134:135] offset:512
    v_cvt_pk_bf16_f32 v20, v108, v109
    v_lshlrev_b32 v108, 16, v20
    v_and_b32 v109, 0xffff0000, v20
    v_add_f32 v108, s55, v108
    v_add_f32 v109, s55, v109
    v_cvt_pk_bf16_f32 v136, v108, v109
    v_cvt_pk_bf16_f32 v20, v110, v111
    v_lshlrev_b32 v110, 16, v20
    v_and_b32 v111, 0xffff0000, v20
    v_add_f32 v110, s55, v110
    v_add_f32 v111, s55, v111
    v_cvt_pk_bf16_f32 v137, v110, v111
    ds_write_b64 v16, v[136:137] offset:1024
    v_cvt_pk_bf16_f32 v20, v112, v113
    v_lshlrev_b32 v112, 16, v20
    v_and_b32 v113, 0xffff0000, v20
    v_add_f32 v112, s55, v112
    v_add_f32 v113, s55, v113
    v_cvt_pk_bf16_f32 v138, v112, v113
    v_cvt_pk_bf16_f32 v20, v114, v115
    v_lshlrev_b32 v114, 16, v20
    v_and_b32 v115, 0xffff0000, v20
    v_add_f32 v114, s55, v114
    v_add_f32 v115, s55, v115
    v_cvt_pk_bf16_f32 v139, v114, v115
    ds_write_b64 v16, v[138:139] offset:1536
    v_cvt_pk_bf16_f32 v20, v116, v117
    v_lshlrev_b32 v116, 16, v20
    v_and_b32 v117, 0xffff0000, v20
    v_add_f32 v116, s55, v116
    v_add_f32 v117, s55, v117
    v_cvt_pk_bf16_f32 v140, v116, v117
    v_cvt_pk_bf16_f32 v20, v118, v119
    v_lshlrev_b32 v118, 16, v20
    v_and_b32 v119, 0xffff0000, v20
    v_add_f32 v118, s55, v118
    v_add_f32 v119, s55, v119
    v_cvt_pk_bf16_f32 v141, v118, v119
    ds_write_b64 v16, v[140:141] offset:2048
    v_cvt_pk_bf16_f32 v20, v120, v121
    v_lshlrev_b32 v120, 16, v20
    v_and_b32 v121, 0xffff0000, v20
    v_add_f32 v120, s55, v120
    v_add_f32 v121, s55, v121
    v_cvt_pk_bf16_f32 v142, v120, v121
    v_cvt_pk_bf16_f32 v20, v122, v123
    v_lshlrev_b32 v122, 16, v20
    v_and_b32 v123, 0xffff0000, v20
    v_add_f32 v122, s55, v122
    v_add_f32 v123, s55, v123
    v_cvt_pk_bf16_f32 v143, v122, v123
    ds_write_b64 v16, v[142:143] offset:2560
    v_cvt_pk_bf16_f32 v20, v124, v125
    v_lshlrev_b32 v124, 16, v20
    v_and_b32 v125, 0xffff0000, v20
    v_add_f32 v124, s55, v124
    v_add_f32 v125, s55, v125
    v_cvt_pk_bf16_f32 v144, v124, v125
    v_cvt_pk_bf16_f32 v20, v126, v127
    v_lshlrev_b32 v126, 16, v20
    v_and_b32 v127, 0xffff0000, v20
    v_add_f32 v126, s55, v126
    v_add_f32 v127, s55, v127
    v_cvt_pk_bf16_f32 v145, v126, v127
    ds_write_b64 v16, v[144:145] offset:3072
    v_cvt_pk_bf16_f32 v20, v128, v129
    v_lshlrev_b32 v128, 16, v20
    v_and_b32 v129, 0xffff0000, v20
    v_add_f32 v128, s55, v128
    v_add_f32 v129, s55, v129
    v_cvt_pk_bf16_f32 v146, v128, v129
    v_cvt_pk_bf16_f32 v20, v130, v131
    v_lshlrev_b32 v130, 16, v20
    v_and_b32 v131, 0xffff0000, v20
    v_add_f32 v130, s55, v130
    v_add_f32 v131, s55, v131
    v_cvt_pk_bf16_f32 v147, v130, v131
    ds_write_b64 v16, v[146:147] offset:3584
L_tb_skip:
    v_and_b32 v16, 127, v0
    v_lshrrev_b32 v17, 7, v0
    v_lshlrev_b32 v15, 14, v17
    v_lshl_add_u32 v15, v16, 4, v15
    s_lshl_b32 s52, s2, 16
    s_add_u32 s52, s52, 135790592
    s_add_u32 s53, s52, 4096
    s_add_u32 s54, s52, 8192
    s_add_u32 s55, s52, 12288
    v_lshlrev_b32 v68, 11, v17
    v_lshl_add_u32 v68, v16, 4, v68
    v_add_u32 v68, 135168, v68
    v_lshlrev_b32 v69, 2, v0
    v_add_u32 v69, 135168, v69
    s_lshl_b32 s57, s3, 3
    s_add_u32 s57, s57, 132224
    v_mov_b32 v70, s57
    v_and_b32 v71, 7, v1
    v_lshlrev_b32 v71, 3, v71
    v_add_u32 v71, 132224, v71
    v_mov_b32 v72, 96256
    v_mov_b32 v73, 33790
    s_mov_b32 s56, 25600
    buffer_load_dwordx4 v[100:103], v15, s[12:15], s52 offen offset:0 sc1
    buffer_load_dwordx4 v[104:107], v15, s[12:15], s52 offen offset:2048 sc1
    buffer_load_dwordx4 v[108:111], v15, s[12:15], s53 offen offset:0 sc1
    buffer_load_dwordx4 v[112:115], v15, s[12:15], s53 offen offset:2048 sc1
    buffer_load_dwordx4 v[116:119], v15, s[12:15], s54 offen offset:0 sc1
    buffer_load_dwordx4 v[120:123], v15, s[12:15], s54 offen offset:2048 sc1
    buffer_load_dwordx4 v[124:127], v15, s[12:15], s55 offen offset:0 sc1
    buffer_load_dwordx4 v[128:131], v15, s[12:15], s55 offen offset:2048 sc1
    s_waitcnt vmcnt(0)
    v_xor_b32 v100, s90, v100
    v_xor_b32 v101, s91, v101
    v_xor_b32 v102, s92, v102
    v_xor_b32 v103, s93, v103
    v_or3_b32 v20, v100, v101, v102
    v_or_b32 v20, v20, v103
    v_and_b32 v20, 0x3ff, v20
    v_cmp_ne_u32 s[64:65], 0, v20
    v_xor_b32 v104, s90, v104
    v_xor_b32 v105, s91, v105
    v_xor_b32 v106, s92, v106
    v_xor_b32 v107, s93, v107
    v_or3_b32 v20, v104, v105, v106
    v_or_b32 v20, v20, v107
    v_and_b32 v20, 0x3ff, v20
    v_cmp_ne_u32 s[66:67], 0, v20
    v_xor_b32 v108, s90, v108
    v_xor_b32 v109, s91, v109
    v_xor_b32 v110, s92, v110
    v_xor_b32 v111, s93, v111
    v_or3_b32 v20, v108, v109, v110
    v_or_b32 v20, v20, v111
    v_and_b32 v20, 0x3ff, v20
    v_cmp_ne_u32 s[68:69], 0, v20
    v_xor_b32 v112, s90, v112
    v_xor_b32 v113, s91, v113
    v_xor_b32 v114, s92, v114
    v_xor_b32 v115, s93, v115
    v_or3_b32 v20, v112, v113, v114
    v_or_b32 v20, v20, v115
    v_and_b32 v20, 0x3ff, v20
    v_cmp_ne_u32 s[70:71], 0, v20
    v_xor_b32 v116, s90, v116
    v_xor_b32 v117, s91, v117
    v_xor_b32 v118, s92, v118
    v_xor_b32 v119, s93, v119
    v_or3_b32 v20, v116, v117, v118
    v_or_b32 v20, v20, v119
    v_and_b32 v20, 0x3ff, v20
    v_cmp_ne_u32 s[72:73], 0, v20
    v_xor_b32 v120, s90, v120
    v_xor_b32 v121, s91, v121
    v_xor_b32 v122, s92, v122
    v_xor_b32 v123, s93, v123
    v_or3_b32 v20, v120, v121, v122
    v_or_b32 v20, v20, v123
    v_and_b32 v20, 0x3ff, v20
    v_cmp_ne_u32 s[74:75], 0, v20
    v_xor_b32 v124, s90, v124
    v_xor_b32 v125, s91, v125
    v_xor_b32 v126, s92, v126
    v_xor_b32 v127, s93, v127
    v_or3_b32 v20, v124, v125, v126
    v_or_b32 v20, v20, v127
    v_and_b32 v20, 0x3ff, v20
    v_cmp_ne_u32 s[76:77], 0, v20
    v_xor_b32 v128, s90, v128
    v_xor_b32 v129, s91, v129
    v_xor_b32 v130, s92, v130
    v_xor_b32 v131, s93, v131
    v_or3_b32 v20, v128, v129, v130
    v_or_b32 v20, v20, v131
    v_and_b32 v20, 0x3ff, v20
    v_cmp_ne_u32 s[78:79], 0, v20
    s_nop 0
    s_or_b64 vcc, s[64:65], s[78:79]
    s_or_b64 vcc, vcc, s[66:67]
    s_or_b64 vcc, vcc, s[68:69]
    s_or_b64 vcc, vcc, s[70:71]
    s_or_b64 vcc, vcc, s[72:73]
    s_or_b64 vcc, vcc, s[74:75]
    s_or_b64 vcc, vcc, s[76:77]
    s_cbranch_scc0 Lpolled_176
    s_mov_b32 s49, 0
Lpoll_175:
    s_mov_b64 exec, s[64:65]
    s_cbranch_execz Lpk_177
    buffer_load_dwordx4 v[100:103], v15, s[12:15], s52 offen offset:0 sc1
Lpk_177:
    s_mov_b64 exec, s[66:67]
    s_cbranch_execz Lpk_178
    buffer_load_dwordx4 v[104:107], v15, s[12:15], s52 offen offset:2048 sc1
Lpk_178:
    s_mov_b64 exec, s[68:69]
    s_cbranch_execz Lpk_179
    buffer_load_dwordx4 v[108:111], v15, s[12:15], s53 offen offset:0 sc1
Lpk_179:
    s_mov_b64 exec, s[70:71]
    s_cbranch_execz Lpk_180
    buffer_load_dwordx4 v[112:115], v15, s[12:15], s53 offen offset:2048 sc1
Lpk_180:
    s_mov_b64 exec, s[72:73]
    s_cbranch_execz Lpk_181
    buffer_load_dwordx4 v[116:119], v15, s[12:15], s54 offen offset:0 sc1
Lpk_181:
    s_mov_b64 exec, s[74:75]
    s_cbranch_execz Lpk_182
    buffer_load_dwordx4 v[120:123], v15, s[12:15], s54 offen offset:2048 sc1
Lpk_182:
    s_mov_b64 exec, s[76:77]
    s_cbranch_execz Lpk_183
    buffer_load_dwordx4 v[124:127], v15, s[12:15], s55 offen offset:0 sc1
Lpk_183:
    s_mov_b64 exec, s[78:79]
    s_cbranch_execz Lpk_184
    buffer_load_dwordx4 v[128:131], v15, s[12:15], s55 offen offset:2048 sc1
Lpk_184:
    s_mov_b64 exec, -1
    s_waitcnt vmcnt(0)
    s_mov_b64 exec, s[64:65]
    s_cbranch_execz Lpc_185
    v_xor_b32 v100, s90, v100
    v_xor_b32 v101, s91, v101
    v_xor_b32 v102, s92, v102
    v_xor_b32 v103, s93, v103
    v_or3_b32 v20, v100, v101, v102
    v_or_b32 v20, v20, v103
    v_and_b32 v20, 0x3ff, v20
    v_cmp_ne_u32 s[64:65], 0, v20
Lpc_185:
    s_mov_b64 exec, s[66:67]
    s_cbranch_execz Lpc_186
    v_xor_b32 v104, s90, v104
    v_xor_b32 v105, s91, v105
    v_xor_b32 v106, s92, v106
    v_xor_b32 v107, s93, v107
    v_or3_b32 v20, v104, v105, v106
    v_or_b32 v20, v20, v107
    v_and_b32 v20, 0x3ff, v20
    v_cmp_ne_u32 s[66:67], 0, v20
Lpc_186:
    s_mov_b64 exec, s[68:69]
    s_cbranch_execz Lpc_187
    v_xor_b32 v108, s90, v108
    v_xor_b32 v109, s91, v109
    v_xor_b32 v110, s92, v110
    v_xor_b32 v111, s93, v111
    v_or3_b32 v20, v108, v109, v110
    v_or_b32 v20, v20, v111
    v_and_b32 v20, 0x3ff, v20
    v_cmp_ne_u32 s[68:69], 0, v20
Lpc_187:
    s_mov_b64 exec, s[70:71]
    s_cbranch_execz Lpc_188
    v_xor_b32 v112, s90, v112
    v_xor_b32 v113, s91, v113
    v_xor_b32 v114, s92, v114
    v_xor_b32 v115, s93, v115
    v_or3_b32 v20, v112, v113, v114
    v_or_b32 v20, v20, v115
    v_and_b32 v20, 0x3ff, v20
    v_cmp_ne_u32 s[70:71], 0, v20
Lpc_188:
    s_mov_b64 exec, s[72:73]
    s_cbranch_execz Lpc_189
    v_xor_b32 v116, s90, v116
    v_xor_b32 v117, s91, v117
    v_xor_b32 v118, s92, v118
    v_xor_b32 v119, s93, v119
    v_or3_b32 v20, v116, v117, v118
    v_or_b32 v20, v20, v119
    v_and_b32 v20, 0x3ff, v20
    v_cmp_ne_u32 s[72:73], 0, v20
Lpc_189:
    s_mov_b64 exec, s[74:75]
    s_cbranch_execz Lpc_190
    v_xor_b32 v120, s90, v120
    v_xor_b32 v121, s91, v121
    v_xor_b32 v122, s92, v122
    v_xor_b32 v123, s93, v123
    v_or3_b32 v20, v120, v121, v122
    v_or_b32 v20, v20, v123
    v_and_b32 v20, 0x3ff, v20
    v_cmp_ne_u32 s[74:75], 0, v20
Lpc_190:
    s_mov_b64 exec, s[76:77]
    s_cbranch_execz Lpc_191
    v_xor_b32 v124, s90, v124
    v_xor_b32 v125, s91, v125
    v_xor_b32 v126, s92, v126
    v_xor_b32 v127, s93, v127
    v_or3_b32 v20, v124, v125, v126
    v_or_b32 v20, v20, v127
    v_and_b32 v20, 0x3ff, v20
    v_cmp_ne_u32 s[76:77], 0, v20
Lpc_191:
    s_mov_b64 exec, s[78:79]
    s_cbranch_execz Lpc_192
    v_xor_b32 v128, s90, v128
    v_xor_b32 v129, s91, v129
    v_xor_b32 v130, s92, v130
    v_xor_b32 v131, s93, v131
    v_or3_b32 v20, v128, v129, v130
    v_or_b32 v20, v20, v131
    v_and_b32 v20, 0x3ff, v20
    v_cmp_ne_u32 s[78:79], 0, v20
Lpc_192:
    s_mov_b64 exec, -1
    s_or_b64 vcc, s[64:65], s[78:79]
    s_or_b64 vcc, vcc, s[66:67]
    s_or_b64 vcc, vcc, s[68:69]
    s_or_b64 vcc, vcc, s[70:71]
    s_or_b64 vcc, vcc, s[72:73]
    s_or_b64 vcc, vcc, s[74:75]
    s_or_b64 vcc, vcc, s[76:77]
    s_cbranch_scc0 Lpolled_176
    s_add_u32 s49, s49, 1
    s_cmp_lt_u32 s49, 4194304
    s_cbranch_scc1 Lpoll_175
Lpolled_176:
    s_nop 1
    v_add_f32 v100, v100, v104
    v_add_f32 v108, v108, v112
    v_add_f32 v116, v116, v120
    v_add_f32 v124, v124, v128
    v_add_f32 v101, v101, v105
    v_add_f32 v109, v109, v113
    v_add_f32 v117, v117, v121
    v_add_f32 v125, v125, v129
    v_add_f32 v102, v102, v106
    v_add_f32 v110, v110, v114
    v_add_f32 v118, v118, v122
    v_add_f32 v126, v126, v130
    v_add_f32 v103, v103, v107
    v_add_f32 v111, v111, v115
    v_add_f32 v119, v119, v123
    v_add_f32 v127, v127, v131
    v_add_f32 v100, v100, v108
    v_add_f32 v116, v116, v124
    v_add_f32 v101, v101, v109
    v_add_f32 v117, v117, v125
    v_add_f32 v102, v102, v110
    v_add_f32 v118, v118, v126
    v_add_f32 v103, v103, v111
    v_add_f32 v119, v119, v127
    v_add_f32 v100, v100, v116
    v_add_f32 v101, v101, v117
    v_add_f32 v102, v102, v118
    v_add_f32 v103, v103, v119
    ds_write_b128 v68, v[100:103]
    v_lshlrev_b32 v164, 16, v164
    s_waitcnt lgkmcnt(0)
    s_barrier
    ds_read2st64_b32 v[100:101], v69 offset0:0 offset1:8
    ds_read2st64_b32 v[102:103], v69 offset0:16 offset1:24
    s_waitcnt lgkmcnt(0)
    v_add_f32 v100, v100, v101
    v_add_f32 v102, v102, v103
    v_add_f32 v100, v100, v102
    v_cvt_pk_bf16_f32 v100, v100, v100
    v_lshlrev_b32 v100, 16, v100
    v_add_f32 v132, v164, v100
    v_cvt_pk_bf16_f32 v132, v132, v132
    v_lshlrev_b32 v132, 16, v132
    s_nop 0
    v_readfirstlane_b32 s57, v132
    s_nop 1
    v_subrev_f32 v134, s57, v132
    v_mul_f32 v135, v134, v134
    s_nop 0
    v_add_f32_dpp v134, v134, v134 quad_perm:[1,0,3,2] row_mask:0xf bank_mask:0xf
    v_add_f32_dpp v135, v135, v135 quad_perm:[1,0,3,2] row_mask:0xf bank_mask:0xf
    s_nop 0
    v_add_f32_dpp v134, v134, v134 quad_perm:[2,3,0,1] row_mask:0xf bank_mask:0xf
    v_add_f32_dpp v135, v135, v135 quad_perm:[2,3,0,1] row_mask:0xf bank_mask:0xf
    s_nop 0
    v_add_f32_dpp v134, v134, v134 row_ror:4 row_mask:0xf bank_mask:0xf
    v_add_f32_dpp v135, v135, v135 row_ror:4 row_mask:0xf bank_mask:0xf
    s_nop 0
    v_add_f32_dpp v134, v134, v134 row_ror:8 row_mask:0xf bank_mask:0xf
    v_add_f32_dpp v135, v135, v135 row_ror:8 row_mask:0xf bank_mask:0xf
    v_mov_b32 v136, v134
    v_mov_b32 v137, v135
    s_nop 0
    v_permlane16_swap_b32 v134, v136
    v_permlane16_swap_b32 v135, v137
    v_add_f32 v134, v134, v136
    v_add_f32 v135, v135, v137
    v_mov_b32 v136, v134
    v_mov_b32 v137, v135
    s_nop 0
    v_permlane32_swap_b32 v134, v136
    v_permlane32_swap_b32 v135, v137
    v_add_f32 v134, v134, v136
    v_add_f32 v135, v135, v137
    v_mul_f32 v136, 0x3c800000, v134
    v_fma_f32 v135, -v136, v134, v135
    v_add_f32 v134, s57, v136
    s_mov_b64 exec, 1
    ds_write_b64 v70, v[134:135]
    s_mov_b64 exec, -1
    s_waitcnt lgkmcnt(0)
    s_barrier
    ds_read_b64 v[134:135], v71
    s_waitcnt lgkmcnt(0)
    v_mov_b32 v137, v134
    s_nop 1
    v_add_f32_dpp v137, v137, v137 quad_perm:[1,0,3,2] row_mask:0xf bank_mask:0xf
    s_nop 1
    v_add_f32_dpp v137, v137, v137 quad_perm:[2,3,0,1] row_mask:0xf bank_mask:0xf
    s_nop 1
    v_add_f32_dpp v137, v137, v137 row_half_mirror row_mask:0xf bank_mask:0xf
    v_mul_f32 v137, 0x3e000000, v137
    v_sub_f32 v134, v134, v137
    v_mul_f32 v134, v134, v134
    v_fmac_f32 v135, 0x42800000, v134
    s_nop 1
    v_add_f32_dpp v135, v135, v135 quad_perm:[1,0,3,2] row_mask:0xf bank_mask:0xf
    s_nop 1
    v_add_f32_dpp v135, v135, v135 quad_perm:[2,3,0,1] row_mask:0xf bank_mask:0xf
    s_nop 1
    v_add_f32_dpp v135, v135, v135 row_half_mirror row_mask:0xf bank_mask:0xf
    v_mul_f32 v135, 0x3b000000, v135
    v_cvt_pk_bf16_f32 v136, v137, v135
    v_lshlrev_b32 v137, 16, v136
    v_and_b32 v135, 0xffff0000, v136
    v_add_f32 v135, 0x3727c5ac, v135
    v_sub_f32 v133, v132, v137
    v_cvt_pk_bf16_f32 v136, v135, v133
    v_lshlrev_b32 v135, 16, v136
    v_and_b32 v133, 0xffff0000, v136
    v_sqrt_f32 v135, v135
    s_nop 0
    v_cvt_pk_bf16_f32 v135, v135, v135
    v_lshlrev_b32 v135, 16, v135
    v_rcp_f32 v135, v135
    s_nop 0
    v_mul_f32 v133, v133, v135
    v_cvt_pk_bf16_f32 v133, v133, v133
    v_lshlrev_b32 v133, 16, v133
    v_mov_b32 v134, v133
    v_mul_f32 v135, v133, v133
    s_nop 0
    v_add_f32_dpp v134, v134, v134 quad_perm:[1,0,3,2] row_mask:0xf bank_mask:0xf
    v_add_f32_dpp v135, v135, v135 quad_perm:[1,0,3,2] row_mask:0xf bank_mask:0xf
    s_nop 0
    v_add_f32_dpp v134, v134, v134 quad_perm:[2,3,0,1] row_mask:0xf bank_mask:0xf
    v_add_f32_dpp v135, v135, v135 quad_perm:[2,3,0,1] row_mask:0xf bank_mask:0xf
    s_nop 0
    v_add_f32_dpp v134, v134, v134 row_ror:4 row_mask:0xf bank_mask:0xf
    v_add_f32_dpp v135, v135, v135 row_ror:4 row_mask:0xf bank_mask:0xf
    s_nop 0
    v_add_f32_dpp v134, v134, v134 row_ror:8 row_mask:0xf bank_mask:0xf
    v_add_f32_dpp v135, v135, v135 row_ror:8 row_mask:0xf bank_mask:0xf
    v_mov_b32 v136, v134
    v_mov_b32 v137, v135
    s_nop 0
    v_permlane16_swap_b32 v134, v136
    v_permlane16_swap_b32 v135, v137
    v_add_f32 v134, v134, v136
    v_add_f32 v135, v135, v137
    v_mov_b32 v136, v134
    v_mov_b32 v137, v135
    s_nop 0
    v_permlane32_swap_b32 v134, v136
    v_permlane32_swap_b32 v135, v137
    v_add_f32 v134, v134, v136
    v_add_f32 v135, v135, v137
    s_mov_b64 exec, 1
    ds_write_b64 v70, v[134:135] offset:64
    s_mov_b64 exec, -1
    s_waitcnt lgkmcnt(0)
    s_barrier
    ds_read_b64 v[134:135], v71 offset:64
    s_waitcnt lgkmcnt(0)
    v_add_f32_dpp v134, v134, v134 quad_perm:[1,0,3,2] row_mask:0xf bank_mask:0xf
    v_add_f32_dpp v135, v135, v135 quad_perm:[1,0,3,2] row_mask:0xf bank_mask:0xf
    s_nop 0
    v_add_f32_dpp v134, v134, v134 quad_perm:[2,3,0,1] row_mask:0xf bank_mask:0xf
    v_add_f32_dpp v135, v135, v135 quad_perm:[2,3,0,1] row_mask:0xf bank_mask:0xf
    s_nop 0
    v_add_f32_dpp v134, v134, v134 row_half_mirror row_mask:0xf bank_mask:0xf
    v_add_f32_dpp v135, v135, v135 row_half_mirror row_mask:0xf bank_mask:0xf
    v_mul_f32 v134, 0x3b000000, v134
    v_mul_f32 v135, 0x3b000000, v135
    v_fma_f32 v135, -v134, v134, v135
    v_cvt_pk_bf16_f32 v136, v134, v135
    v_lshlrev_b32 v134, 16, v136
    v_and_b32 v135, 0xffff0000, v136
    v_add_f32 v135, 0x3727c5ac, v135
    v_sub_f32 v133, v133, v134
    v_cvt_pk_bf16_f32 v136, v135, v133
    v_lshlrev_b32 v135, 16, v136
    v_and_b32 v133, 0xffff0000, v136
    v_sqrt_f32 v135, v135
    s_nop 0
    v_cvt_pk_bf16_f32 v135, v135, v135
    v_lshlrev_b32 v135, 16, v135
    v_rcp_f32 v135, v135
    s_nop 0
    v_mul_f32 v133, v133, v135
    v_cvt_pk_bf16_f32 v133, v133, v133
    v_lshlrev_b32 v133, 16, v133
    v_alignbit_b32 v100, v133, v133, 31
    v_lshrrev_b32 v101, 16, v100
    v_med3_u32 v102, v101, s56, v73
    v_and_or_b32 v102, v100, 1, v102
    v_lshl_add_u32 v102, v102, 1, v72
    ds_read_u16 v100, v102
    v_cmp_lt_u32 vcc, v73, v101
    v_add_u32 v101, -1, v101
    v_cmp_gt_u32 s[52:53], s56, v101
    s_lshl_b32 s57, s2, 10
    s_or_b64 vcc, vcc, s[52:53]
    s_cbranch_scc1 L_fb1
    s_waitcnt lgkmcnt(0)
    v_lshlrev_b32 v100, 16, v100
    v_add_f32 v100, v100, v132
    v_cvt_pk_bf16_f32 v100, v100, v100
    buffer_store_short v100, v12, s[28:31], s57 offen sc0 sc1
L_fin:
    s_or_b32 s57, s2, s3
    s_cbranch_scc1 L_noE
    s_add_u32 s57, s100, 1
    v_mov_b32 v52, s57
    v_mov_b32 v53, 0
    s_mov_b32 s57, 136839168
    s_mov_b64 exec, 1
    buffer_store_dword v52, v53, s[12:15], s57 offen sc1
    s_mov_b64 exec, -1
L_noE:
    s_endpgm
L_fb1:
    s_waitcnt lgkmcnt(0)
    v_mov_b32 v101, 0
    v_mov_b32 v103, 0xc0135761
    v_mov_b32 v104, 0xbdd2d3e8
    s_mov_b32 s57, 0
    s_load_dword s52, s[42:43], 0
L_mix:
    s_load_dwordx8 s[64:71], s[36:37], s57
    s_load_dwordx8 s[72:79], s[38:39], s57
    s_load_dwordx8 s[80:87], s[40:41], s57
    s_waitcnt lgkmcnt(0)
    s_lshl_b32 s88, s64, 16
    s_lshl_b32 s89, s72, 16
    s_lshl_b32 s90, s80, 16
    v_mul_f32 v108, s88, v133
    v_add_f32 v108, s89, v108
    v_mul_f32 v109, v108, v108
    v_fma_f32 v109, v109, v104, v103
    v_mul_f32 v109, v109, v108
    v_exp_f32 v109, v109
    s_nop 0
    v_add_f32 v109, 1.0, v109
    v_rcp_f32 v109, v109
    s_nop 0
    v_mul_f32 v109, v109, v108
    v_fmac_f32 v101, s90, v109
    s_and_b32 s88, s64, 0xffff0000
    s_and_b32 s89, s72, 0xffff0000
    s_and_b32 s90, s80, 0xffff0000
    v_mul_f32 v108, s88, v133
    v_add_f32 v108, s89, v108
    v_mul_f32 v109, v108, v108
    v_fma_f32 v109, v109, v104, v103
    v_mul_f32 v109, v109, v108
    v_exp_f32 v109, v109
    s_nop 0
    v_add_f32 v109, 1.0, v109
    v_rcp_f32 v109, v109
    s_nop 0
    v_mul_f32 v109, v109, v108
    v_fmac_f32 v101, s90, v109
    s_lshl_b32 s88, s65, 16
    s_lshl_b32 s89, s73, 16
    s_lshl_b32 s90, s81, 16
    v_mul_f32 v108, s88, v133
    v_add_f32 v108, s89, v108
    v_mul_f32 v109, v108, v108
    v_fma_f32 v109, v109, v104, v103
    v_mul_f32 v109, v109, v108
    v_exp_f32 v109, v109
    s_nop 0
    v_add_f32 v109, 1.0, v109
    v_rcp_f32 v109, v109
    s_nop 0
    v_mul_f32 v109, v109, v108
    v_fmac_f32 v101, s90, v109
    s_and_b32 s88, s65, 0xffff0000
    s_and_b32 s89, s73, 0xffff0000
    s_and_b32 s90, s81, 0xffff0000
    v_mul_f32 v108, s88, v133
    v_add_f32 v108, s89, v108
    v_mul_f32 v109, v108, v108
    v_fma_f32 v109, v109, v104, v103
    v_mul_f32 v109, v109, v108
    v_exp_f32 v109, v109
    s_nop 0
    v_add_f32 v109, 1.0, v109
    v_rcp_f32 v109, v109
    s_nop 0
    v_mul_f32 v109, v109, v108
    v_fmac_f32 v101, s90, v109
    s_lshl_b32 s88, s66, 16
    s_lshl_b32 s89, s74, 16
    s_lshl_b32 s90, s82, 16
    v_mul_f32 v108, s88, v133
    v_add_f32 v108, s89, v108
    v_mul_f32 v109, v108, v108
    v_fma_f32 v109, v109, v104, v103
    v_mul_f32 v109, v109, v108
    v_exp_f32 v109, v109
    s_nop 0
    v_add_f32 v109, 1.0, v109
    v_rcp_f32 v109, v109
    s_nop 0
    v_mul_f32 v109, v109, v108
    v_fmac_f32 v101, s90, v109
    s_and_b32 s88, s66, 0xffff0000
    s_and_b32 s89, s74, 0xffff0000
    s_and_b32 s90, s82, 0xffff0000
    v_mul_f32 v108, s88, v133
    v_add_f32 v108, s89, v108
    v_mul_f32 v109, v108, v108
    v_fma_f32 v109, v109, v104, v103
    v_mul_f32 v109, v109, v108
    v_exp_f32 v109, v109
    s_nop 0
    v_add_f32 v109, 1.0, v109
    v_rcp_f32 v109, v109
    s_nop 0
    v_mul_f32 v109, v109, v108
    v_fmac_f32 v101, s90, v109
    s_lshl_b32 s88, s67, 16
    s_lshl_b32 s89, s75, 16
    s_lshl_b32 s90, s83, 16
    v_mul_f32 v108, s88, v133
    v_add_f32 v108, s89, v108
    v_mul_f32 v109, v108, v108
    v_fma_f32 v109, v109, v104, v103
    v_mul_f32 v109, v109, v108
    v_exp_f32 v109, v109
    s_nop 0
    v_add_f32 v109, 1.0, v109
    v_rcp_f32 v109, v109
    s_nop 0
    v_mul_f32 v109, v109, v108
    v_fmac_f32 v101, s90, v109
    s_and_b32 s88, s67, 0xffff0000
    s_and_b32 s89, s75, 0xffff0000
    s_and_b32 s90, s83, 0xffff0000
    v_mul_f32 v108, s88, v133
    v_add_f32 v108, s89, v108
    v_mul_f32 v109, v108, v108
    v_fma_f32 v109, v109, v104, v103
    v_mul_f32 v109, v109, v108
    v_exp_f32 v109, v109
    s_nop 0
    v_add_f32 v109, 1.0, v109
    v_rcp_f32 v109, v109
    s_nop 0
    v_mul_f32 v109, v109, v108
    v_fmac_f32 v101, s90, v109
    s_lshl_b32 s88, s68, 16
    s_lshl_b32 s89, s76, 16
    s_lshl_b32 s90, s84, 16
    v_mul_f32 v108, s88, v133
    v_add_f32 v108, s89, v108
    v_mul_f32 v109, v108, v108
    v_fma_f32 v109, v109, v104, v103
    v_mul_f32 v109, v109, v108
    v_exp_f32 v109, v109
    s_nop 0
    v_add_f32 v109, 1.0, v109
    v_rcp_f32 v109, v109
    s_nop 0
    v_mul_f32 v109, v109, v108
    v_fmac_f32 v101, s90, v109
    s_and_b32 s88, s68, 0xffff0000
    s_and_b32 s89, s76, 0xffff0000
    s_and_b32 s90, s84, 0xffff0000
    v_mul_f32 v108, s88, v133
    v_add_f32 v108, s89, v108
    v_mul_f32 v109, v108, v108
    v_fma_f32 v109, v109, v104, v103
    v_mul_f32 v109, v109, v108
    v_exp_f32 v109, v109
    s_nop 0
    v_add_f32 v109, 1.0, v109
    v_rcp_f32 v109, v109
    s_nop 0
    v_mul_f32 v109, v109, v108
    v_fmac_f32 v101, s90, v109
    s_lshl_b32 s88, s69, 16
    s_lshl_b32 s89, s77, 16
    s_lshl_b32 s90, s85, 16
    v_mul_f32 v108, s88, v133
    v_add_f32 v108, s89, v108
    v_mul_f32 v109, v108, v108
    v_fma_f32 v109, v109, v104, v103
    v_mul_f32 v109, v109, v108
    v_exp_f32 v109, v109
    s_nop 0
    v_add_f32 v109, 1.0, v109
    v_rcp_f32 v109, v109
    s_nop 0
    v_mul_f32 v109, v109, v108
    v_fmac_f32 v101, s90, v109
    s_and_b32 s88, s69, 0xffff0000
    s_and_b32 s89, s77, 0xffff0000
    s_and_b32 s90, s85, 0xffff0000
    v_mul_f32 v108, s88, v133
    v_add_f32 v108, s89, v108
    v_mul_f32 v109, v108, v108
    v_fma_f32 v109, v109, v104, v103
    v_mul_f32 v109, v109, v108
    v_exp_f32 v109, v109
    s_nop 0
    v_add_f32 v109, 1.0, v109
    v_rcp_f32 v109, v109
    s_nop 0
    v_mul_f32 v109, v109, v108
    v_fmac_f32 v101, s90, v109
    s_lshl_b32 s88, s70, 16
    s_lshl_b32 s89, s78, 16
    s_lshl_b32 s90, s86, 16
    v_mul_f32 v108, s88, v133
    v_add_f32 v108, s89, v108
    v_mul_f32 v109, v108, v108
    v_fma_f32 v109, v109, v104, v103
    v_mul_f32 v109, v109, v108
    v_exp_f32 v109, v109
    s_nop 0
    v_add_f32 v109, 1.0, v109
    v_rcp_f32 v109, v109
    s_nop 0
    v_mul_f32 v109, v109, v108
    v_fmac_f32 v101, s90, v109
    s_and_b32 s88, s70, 0xffff0000
    s_and_b32 s89, s78, 0xffff0000
    s_and_b32 s90, s86, 0xffff0000
    v_mul_f32 v108, s88, v133
    v_add_f32 v108, s89, v108
    v_mul_f32 v109, v108, v108
    v_fma_f32 v109, v109, v104, v103
    v_mul_f32 v109, v109, v108
    v_exp_f32 v109, v109
    s_nop 0
    v_add_f32 v109, 1.0, v109
    v_rcp_f32 v109, v109
    s_nop 0
    v_mul_f32 v109, v109, v108
    v_fmac_f32 v101, s90, v109
    s_lshl_b32 s88, s71, 16
    s_lshl_b32 s89, s79, 16
    s_lshl_b32 s90, s87, 16
    v_mul_f32 v108, s88, v133
    v_add_f32 v108, s89, v108
    v_mul_f32 v109, v108, v108
    v_fma_f32 v109, v109, v104, v103
    v_mul_f32 v109, v109, v108
    v_exp_f32 v109, v109
    s_nop 0
    v_add_f32 v109, 1.0, v109
    v_rcp_f32 v109, v109
    s_nop 0
    v_mul_f32 v109, v109, v108
    v_fmac_f32 v101, s90, v109
    s_and_b32 s88, s71, 0xffff0000
    s_and_b32 s89, s79, 0xffff0000
    s_and_b32 s90, s87, 0xffff0000
    v_mul_f32 v108, s88, v133
    v_add_f32 v108, s89, v108
    v_mul_f32 v109, v108, v108
    v_fma_f32 v109, v109, v104, v103
    v_mul_f32 v109, v109, v108
    v_exp_f32 v109, v109
    s_nop 0
    v_add_f32 v109, 1.0, v109
    v_rcp_f32 v109, v109
    s_nop 0
    v_mul_f32 v109, v109, v108
    v_fmac_f32 v101, s90, v109
    s_add_u32 s57, s57, 32
    s_cmp_lt_u32 s57, 3584
    s_cbranch_scc1 L_mix
    v_cvt_pk_bf16_f32 v101, v101, v101
    v_lshlrev_b32 v101, 16, v101
    s_lshl_b32 s52, s52, 16
    v_add_f32 v101, s52, v101
    v_cvt_pk_bf16_f32 v101, v101, v101
    v_lshlrev_b32 v101, 16, v101
    v_add_f32 v101, v101, v132
    v_cvt_pk_bf16_f32 v101, v101, v101
    s_lshl_b32 s57, s2, 10
    buffer_store_short v101, v12, s[28:31], s57 offen
    s_branch L_fin
L_service:
    s_memrealtime s[98:99]
    s_nop 1
    s_setprio 3
    s_sub_u32 s34, s3, 8
    v_mov_b32 v164, 132096
    v_lshlrev_b32 v159, 5, v1
    s_lshl_b32 s55, s34, 11
    buffer_load_dwordx4 v[72:75], v159, s[16:19], s55 offen
    buffer_load_dwordx4 v[76:79], v159, s[16:19], s55 offen offset:16
    v_lshrrev_b32 v156, 3, v1
    v_and_b32 v157, 7, v1
    v_lshlrev_b32 v157, 4, v157
    v_lshl_add_u32 v160, v156, 13, v157
    s_lshl_b32 s53, s94, 10
    s_xor_b32 s54, s101, 5
    s_lshl_b32 s54, s54, 7
    s_add_u32 s53, s53, s54
    s_lshl_b32 s55, s95, 20
    s_add_u32 s55, s55, s53
    s_lshl_b32 s54, s34, 18
    s_add_u32 s55, s55, s54
    s_lshl_b32 s57, s34, 12
    s_add_u32 s57, s57, 147456
    s_add_u32 m0, s57, 0
    s_nop 0
    buffer_load_dwordx4 v160, s[20:23], s55 offen nt lds
    s_add_u32 m0, s57, 1024
    v_xor_b32 v156, 32, v160
    s_add_u32 s56, s55, 65536
    buffer_load_dwordx4 v156, s[20:23], s56 offen nt lds
    s_add_u32 m0, s57, 2048
    v_xor_b32 v156, 64, v160
    s_add_u32 s56, s55, 131072
    buffer_load_dwordx4 v156, s[20:23], s56 offen nt lds
    s_add_u32 m0, s57, 3072
    v_xor_b32 v156, 96, v160
    s_add_u32 s56, s55, 196608
    buffer_load_dwordx4 v156, s[20:23], s56 offen nt lds
L_purej:
    s_barrier
    v_xor_b32 v161, s34, v2
    v_lshlrev_b32 v161, 5, v161
    v_lshl_add_u32 v161, v2, 10, v161
    v_lshl_add_u32 v161, v3, 1, v161
    v_add_u32 v161, 147456, v161
    s_waitcnt vmcnt(4)
    v_lshlrev_b32 v92, 16, v72
    v_and_b32 v93, 0xffff0000, v72
    v_lshlrev_b32 v94, 16, v73
    v_and_b32 v95, 0xffff0000, v73
    v_lshlrev_b32 v96, 16, v74
    v_and_b32 v97, 0xffff0000, v74
    v_lshlrev_b32 v98, 16, v75
    v_and_b32 v99, 0xffff0000, v75
    v_lshlrev_b32 v100, 16, v76
    v_and_b32 v101, 0xffff0000, v76
    v_lshlrev_b32 v102, 16, v77
    v_and_b32 v103, 0xffff0000, v77
    v_lshlrev_b32 v104, 16, v78
    v_and_b32 v105, 0xffff0000, v78
    v_lshlrev_b32 v106, 16, v79
    v_and_b32 v107, 0xffff0000, v79
    v_add_f32 v156, v92, v93
    v_add_f32 v156, v156, v94
    v_add_f32 v156, v156, v95
    v_add_f32 v156, v156, v96
    v_add_f32 v156, v156, v97
    v_add_f32 v156, v156, v98
    v_add_f32 v156, v156, v99
    v_add_f32 v156, v156, v100
    v_add_f32 v156, v156, v101
    v_add_f32 v156, v156, v102
    v_add_f32 v156, v156, v103
    v_add_f32 v156, v156, v104
    v_add_f32 v156, v156, v105
    v_add_f32 v156, v156, v106
    v_add_f32 v156, v156, v107
    s_nop 1
    v_add_f32_dpp v156, v156, v156 quad_perm:[1,0,3,2] row_mask:0xf bank_mask:0xf
    s_nop 1
    v_add_f32_dpp v156, v156, v156 quad_perm:[2,3,0,1] row_mask:0xf bank_mask:0xf
    s_nop 1
    v_add_f32_dpp v156, v156, v156 row_ror:4 row_mask:0xf bank_mask:0xf
    s_nop 1
    v_add_f32_dpp v156, v156, v156 row_ror:8 row_mask:0xf bank_mask:0xf
    v_mov_b32 v157, v156
    s_nop 1
    v_permlane16_swap_b32 v156, v157
    v_add_f32 v156, v156, v157
    v_mul_f32 v156, 0x3b000000, v156
    v_sub_f32 v157, v92, v156
    v_mul_f32 v158, v157, v157
    v_sub_f32 v157, v93, v156
    v_fmac_f32 v158, v157, v157
    v_sub_f32 v157, v94, v156
    v_fmac_f32 v158, v157, v157
    v_sub_f32 v157, v95, v156
    v_fmac_f32 v158, v157, v157
    v_sub_f32 v157, v96, v156
    v_fmac_f32 v158, v157, v157
    v_sub_f32 v157, v97, v156
    v_fmac_f32 v158, v157, v157
    v_sub_f32 v157, v98, v156
    v_fmac_f32 v158, v157, v157
    v_sub_f32 v157, v99, v156
    v_fmac_f32 v158, v157, v157
    v_sub_f32 v157, v100, v156
    v_fmac_f32 v158, v157, v157
    v_sub_f32 v157, v101, v156
    v_fmac_f32 v158, v157, v157
    v_sub_f32 v157, v102, v156
    v_fmac_f32 v158, v157, v157
    v_sub_f32 v157, v103, v156
    v_fmac_f32 v158, v157, v157
    v_sub_f32 v157, v104, v156
    v_fmac_f32 v158, v157, v157
    v_sub_f32 v157, v105, v156
    v_fmac_f32 v158, v157, v157
    v_sub_f32 v157, v106, v156
    v_fmac_f32 v158, v157, v157
    v_sub_f32 v157, v107, v156
    v_fmac_f32 v158, v157, v157
    s_nop 1
    v_add_f32_dpp v158, v158, v158 quad_perm:[1,0,3,2] row_mask:0xf bank_mask:0xf
    s_nop 1
    v_add_f32_dpp v158, v158, v158 quad_perm:[2,3,0,1] row_mask:0xf bank_mask:0xf
    s_nop 1
    v_add_f32_dpp v158, v158, v158 row_ror:4 row_mask:0xf bank_mask:0xf
    s_nop 1
    v_add_f32_dpp v158, v158, v158 row_ror:8 row_mask:0xf bank_mask:0xf
    v_mov_b32 v157, v158
    s_nop 1
    v_permlane16_swap_b32 v158, v157
    v_add_f32 v158, v158, v157
    v_mul_f32 v158, 0x3b000000, v158
    v_cvt_pk_bf16_f32 v157, v156, v158
    v_lshlrev_b32 v156, 16, v157
    v_and_b32 v158, 0xffff0000, v157
    v_add_f32 v158, 0x3727c5ac, v158
    v_cvt_pk_bf16_f32 v158, v158, v158
    v_lshlrev_b32 v158, 16, v158
    v_sqrt_f32 v158, v158
    s_nop 0
    v_cvt_pk_bf16_f32 v158, v158, v158
    v_lshlrev_b32 v158, 16, v158
    v_rcp_f32 v158, v158
    v_sub_f32 v92, v92, v156
    v_sub_f32 v93, v93, v156
    v_cvt_pk_bf16_f32 v157, v92, v93
    v_lshlrev_b32 v92, 16, v157
    v_and_b32 v93, 0xffff0000, v157
    v_mul_f32 v92, v92, v158
    v_mul_f32 v93, v93, v158
    v_cvt_pk_bf16_f32 v72, v92, v93
    v_sub_f32 v94, v94, v156
    v_sub_f32 v95, v95, v156
    v_cvt_pk_bf16_f32 v157, v94, v95
    v_lshlrev_b32 v94, 16, v157
    v_and_b32 v95, 0xffff0000, v157
    v_mul_f32 v94, v94, v158
    v_mul_f32 v95, v95, v158
    v_cvt_pk_bf16_f32 v73, v94, v95
    v_sub_f32 v96, v96, v156
    v_sub_f32 v97, v97, v156
    v_cvt_pk_bf16_f32 v157, v96, v97
    v_lshlrev_b32 v96, 16, v157
    v_and_b32 v97, 0xffff0000, v157
    v_mul_f32 v96, v96, v158
    v_mul_f32 v97, v97, v158
    v_cvt_pk_bf16_f32 v74, v96, v97
    v_sub_f32 v98, v98, v156
    v_sub_f32 v99, v99, v156
    v_cvt_pk_bf16_f32 v157, v98, v99
    v_lshlrev_b32 v98, 16, v157
    v_and_b32 v99, 0xffff0000, v157
    v_mul_f32 v98, v98, v158
    v_mul_f32 v99, v99, v158
    v_cvt_pk_bf16_f32 v75, v98, v99
    v_sub_f32 v100, v100, v156
    v_sub_f32 v101, v101, v156
    v_cvt_pk_bf16_f32 v157, v100, v101
    v_lshlrev_b32 v100, 16, v157
    v_and_b32 v101, 0xffff0000, v157
    v_mul_f32 v100, v100, v158
    v_mul_f32 v101, v101, v158
    v_cvt_pk_bf16_f32 v76, v100, v101
    v_sub_f32 v102, v102, v156
    v_sub_f32 v103, v103, v156
    v_cvt_pk_bf16_f32 v157, v102, v103
    v_lshlrev_b32 v102, 16, v157
    v_and_b32 v103, 0xffff0000, v157
    v_mul_f32 v102, v102, v158
    v_mul_f32 v103, v103, v158
    v_cvt_pk_bf16_f32 v77, v102, v103
    v_sub_f32 v104, v104, v156
    v_sub_f32 v105, v105, v156
    v_cvt_pk_bf16_f32 v157, v104, v105
    v_lshlrev_b32 v104, 16, v157
    v_and_b32 v105, 0xffff0000, v157
    v_mul_f32 v104, v104, v158
    v_mul_f32 v105, v105, v158
    v_cvt_pk_bf16_f32 v78, v104, v105
    v_sub_f32 v106, v106, v156
    v_sub_f32 v107, v107, v156
    v_cvt_pk_bf16_f32 v157, v106, v107
    v_lshlrev_b32 v106, 16, v157
    v_and_b32 v107, 0xffff0000, v157
    v_mul_f32 v106, v106, v158
    v_mul_f32 v107, v107, v158
    v_cvt_pk_bf16_f32 v79, v106, v107
    s_lshl_b32 s56, s34, 11
    s_add_u32 s56, s56, 135168
    v_add_u32 v159, s56, v159
    ds_write_b128 v159, v[72:75]
    ds_write_b128 v159, v[76:79] offset:16
    v_and_b32 v157, 7, v3
    v_lshlrev_b32 v157, 10, v157
    v_lshl_add_u32 v157, v2, 4, v157
    s_lshl_b32 s56, s95, 8
    s_add_u32 s56, s56, 135168
    v_add_u32 v157, s56, v157
    v_lshlrev_b32 v159, 16, v3
    v_lshl_add_u32 v159, v2, 4, v159
    s_lshl_b32 s56, s53, 1
    s_lshl_b32 s55, s95, 14
    s_add_u32 s56, s56, s55
    s_lshl_b32 s55, s34, 6
    s_add_u32 s56, s56, s55
    s_add_u32 s56, s56, 134217728
    s_waitcnt vmcnt(0)
    s_mov_b64 exec, 1
    v_mov_b32 v156, 1
    s_waitcnt lgkmcnt(0)
    ds_add_u32 v164, v156 offset:24
    s_mov_b64 exec, -1
    s_waitcnt lgkmcnt(0)
    s_mul_i32 s50, s100, 0x9E3779B1
    s_add_u32 s50, s50, 0x85EBCA6B
    s_and_b32 s90, s50, 0x3ff
    s_lshr_b32 s91, s50, 10
    s_and_b32 s91, s91, 0x3ff
    s_lshr_b32 s92, s50, 20
    s_and_b32 s92, s92, 0x3ff
    s_lshr_b32 s93, s50, 30
    s_lshl_b32 s93, s93, 8
    s_andn2_b32 s50, 0xff, s50
    s_or_b32 s93, s93, s50
    s_lshl_b32 s98, s98, 10
    s_lshr_b32 s96, s33, 3
    s_xor_b32 s97, s34, 2
    s_or_b32 s96, s96, s97
    s_cbranch_scc1 L_not0w
    v_mov_b32 v148, s98
    v_mov_b32 v149, s98
    v_mov_b32 v150, s98
    v_mov_b32 v151, s98
    v_or_b32 v148, s90, v148
    v_or_b32 v149, s91, v149
    v_or_b32 v150, s92, v150
    v_or_b32 v151, s93, v151
    v_mov_b32 v152, 0
    s_lshl_b32 s96, s33, 4
    s_add_u32 s96, s96, 136839424
    s_mov_b64 exec, 1
    buffer_store_dwordx4 v[148:151], v152, s[12:15], s96 offen sc1
    s_mov_b64 exec, -1
L_not0w:
    s_mov_b32 s49, 0
Lspin_193:
    ds_read_b32 v156, v164 offset:24
    s_waitcnt lgkmcnt(0)
    v_readfirstlane_b32 s50, v156
    s_nop 0
    s_cmp_eq_u32 s50, 4
    s_cbranch_scc1 Lspun_194
    s_add_u32 s49, s49, 1
    s_cmp_lt_u32 s49, 4194304
    s_cbranch_scc1 Lspin_193
Lspun_194:
    ds_read_u16 v24, v161 offset:0
    ds_read_u16 v25, v161 offset:128
    ds_read_u16 v26, v161 offset:256
    ds_read_u16 v27, v161 offset:384
    ds_read_u16 v28, v161 offset:512
    ds_read_u16 v29, v161 offset:640
    ds_read_u16 v30, v161 offset:768
    ds_read_u16 v31, v161 offset:896
    ds_read_u16 v32, v161 offset:4096
    ds_read_u16 v33, v161 offset:4224
    ds_read_u16 v34, v161 offset:4352
    ds_read_u16 v35, v161 offset:4480
    ds_read_u16 v36, v161 offset:4608
    ds_read_u16 v37, v161 offset:4736
    ds_read_u16 v38, v161 offset:4864
    ds_read_u16 v39, v161 offset:4992
    s_waitcnt lgkmcnt(8)
    v_lshl_or_b32 v56, v25, 16, v24
    v_lshl_or_b32 v57, v27, 16, v26
    v_lshl_or_b32 v58, v29, 16, v28
    v_lshl_or_b32 v59, v31, 16, v30
    ds_read_u16 v40, v161 offset:8192
    ds_read_u16 v41, v161 offset:8320
    ds_read_u16 v42, v161 offset:8448
    ds_read_u16 v43, v161 offset:8576
    ds_read_u16 v44, v161 offset:8704
    ds_read_u16 v45, v161 offset:8832
    ds_read_u16 v46, v161 offset:8960
    ds_read_u16 v47, v161 offset:9088
    s_waitcnt lgkmcnt(8)
    v_lshl_or_b32 v60, v33, 16, v32
    v_lshl_or_b32 v61, v35, 16, v34
    v_lshl_or_b32 v62, v37, 16, v36
    v_lshl_or_b32 v63, v39, 16, v38
    ds_read_u16 v48, v161 offset:12288
    ds_read_u16 v49, v161 offset:12416
    ds_read_u16 v50, v161 offset:12544
    ds_read_u16 v51, v161 offset:12672
    ds_read_u16 v52, v161 offset:12800
    ds_read_u16 v53, v161 offset:12928
    ds_read_u16 v54, v161 offset:13056
    ds_read_u16 v55, v161 offset:13184
    s_waitcnt lgkmcnt(8)
    v_lshl_or_b32 v64, v41, 16, v40
    v_lshl_or_b32 v65, v43, 16, v42
    v_lshl_or_b32 v66, v45, 16, v44
    v_lshl_or_b32 v67, v47, 16, v46
    ds_read_b128 v[72:75], v157 offset:0
    ds_read_b128 v[76:79], v157 offset:64
    ds_read_b128 v[80:83], v157 offset:128
    ds_read_b128 v[84:87], v157 offset:192
    s_waitcnt lgkmcnt(4)
    v_lshl_or_b32 v68, v49, 16, v48
    v_lshl_or_b32 v69, v51, 16, v50
    v_lshl_or_b32 v70, v53, 16, v52
    v_lshl_or_b32 v71, v55, 16, v54
    s_waitcnt lgkmcnt(3)
    v_mfma_f32_16x16x32_bf16 v[88:91], v[56:59], v[72:75], 0
    s_waitcnt lgkmcnt(2)
    v_mfma_f32_16x16x32_bf16 v[88:91], v[60:63], v[76:79], v[88:91]
    s_waitcnt lgkmcnt(1)
    v_mfma_f32_16x16x32_bf16 v[88:91], v[64:67], v[80:83], v[88:91]
    s_waitcnt lgkmcnt(0)
    v_mfma_f32_16x16x32_bf16 v[88:91], v[68:71], v[84:87], v[88:91]
    s_nop 7
    v_add_u32 v88, 0x200, v88
    v_and_b32 v88, 0xfffffc00, v88
    v_or_b32 v88, s90, v88
    v_add_u32 v89, 0x200, v89
    v_and_b32 v89, 0xfffffc00, v89
    v_or_b32 v89, s91, v89
    v_add_u32 v90, 0x200, v90
    v_and_b32 v90, 0xfffffc00, v90
    v_or_b32 v90, s92, v90
    v_add_u32 v91, 0x200, v91
    v_and_b32 v91, 0xfffffc00, v91
    v_or_b32 v91, s93, v91
    s_mov_b32 s58, 0x00ff00ff
    s_mov_b32 s59, 0x00ff00ff
    s_mov_b64 exec, s[58:59]
    buffer_store_dwordx4 v[88:91], v159, s[12:15], s56 offen sc1
    s_mov_b64 exec, 1
    v_mov_b32 v156, 1
    s_waitcnt lgkmcnt(0)
    ds_add_u32 v164, v156 offset:28
    s_mov_b64 exec, -1
    s_mul_i32 s35, s34, 896
    v_lshl_add_u32 v158, v1, 1, s35
    v_and_b32 v156, 1, v1
    v_cmp_eq_u32 vcc, 1, v156
    v_mov_b32 v32, s90
    v_mov_b32 v157, s92
    v_cndmask_b32 v32, v32, v157, vcc
    v_mov_b32 v33, s91
    v_mov_b32 v157, s93
    v_cndmask_b32 v33, v33, v157, vcc
    s_lshl_b32 s53, s45, 16
    s_lshl_b32 s54, s44, 11
    s_add_u32 s53, s53, s54
    s_lshl_b32 s54, s34, 9
    s_add_u32 s53, s53, s54
    s_add_u32 s53, s53, 134217728
    s_add_u32 s54, s53, 16384
    s_add_u32 s55, s53, 32768
    s_add_u32 s56, s53, 49152
    v_lshlrev_b32 v159, 3, v1
    s_mov_b32 s49, 0
    global_load_ushort v82, v158, s[36:37] offset:0
    global_load_ushort v96, v158, s[38:39] offset:0
    global_load_ushort v110, v158, s[40:41] offset:0
    global_load_ushort v84, v158, s[36:37] offset:128
    global_load_ushort v98, v158, s[38:39] offset:128
    global_load_ushort v112, v158, s[40:41] offset:128
    global_load_ushort v86, v158, s[36:37] offset:256
    global_load_ushort v100, v158, s[38:39] offset:256
    global_load_ushort v114, v158, s[40:41] offset:256
    global_load_ushort v88, v158, s[36:37] offset:384
    global_load_ushort v102, v158, s[38:39] offset:384
    global_load_ushort v116, v158, s[40:41] offset:384
    global_load_ushort v90, v158, s[36:37] offset:512
    global_load_ushort v104, v158, s[38:39] offset:512
    global_load_ushort v118, v158, s[40:41] offset:512
    global_load_ushort v92, v158, s[36:37] offset:640
    global_load_ushort v106, v158, s[38:39] offset:640
    global_load_ushort v120, v158, s[40:41] offset:640
    global_load_ushort v94, v158, s[36:37] offset:768
    global_load_ushort v108, v158, s[38:39] offset:768
    global_load_ushort v122, v158, s[40:41] offset:768
    s_waitcnt vmcnt(0)
    s_cmp_eq_u32 s34, 1
    s_cselect_b32 s96, 0xff, 0
    s_mov_b32 s97, 0
    s_mov_b32 s99, 136839424
    v_lshlrev_b32 v35, 4, v1
L_qpoll:
    s_mov_b64 exec, s[96:97]
    s_cbranch_execz L_not0l
    buffer_load_dwordx4 v[36:39], v35, s[12:15], s99 offen sc1
L_not0l:
    s_mov_b64 exec, -1
    buffer_load_dwordx2 v[24:25], v159, s[12:15], s53 offen sc1
    buffer_load_dwordx2 v[26:27], v159, s[12:15], s54 offen sc1
    buffer_load_dwordx2 v[28:29], v159, s[12:15], s55 offen sc1
    buffer_load_dwordx2 v[30:31], v159, s[12:15], s56 offen sc1
    s_waitcnt vmcnt(0)
    v_xor_b32 v24, v24, v32
    v_xor_b32 v25, v25, v33
    v_xor_b32 v26, v26, v32
    v_xor_b32 v27, v27, v33
    v_xor_b32 v28, v28, v32
    v_xor_b32 v29, v29, v33
    v_xor_b32 v30, v30, v32
    v_xor_b32 v31, v31, v33
    v_or3_b32 v34, v24, v25, v26
    v_or3_b32 v34, v34, v27, v28
    v_or3_b32 v34, v34, v29, v30
    v_or_b32 v34, v34, v31
    v_and_b32 v34, 0x3ff, v34
    v_cmp_ne_u32 vcc, 0, v34
    s_nop 0
    s_cbranch_vccz L_qgot
    s_sleep 16
    s_add_u32 s49, s49, 1
    s_cmp_lt_u32 s49, 4194304
    s_cbranch_scc1 L_qpoll
L_qgot:
    v_add_f32 v24, v24, v26
    v_add_f32 v28, v28, v30
    v_add_f32 v24, v24, v28
    v_add_f32 v25, v25, v27
    v_add_f32 v29, v29, v31
    v_add_f32 v25, v25, v29
    v_cvt_pk_bf16_f32 v24, v24, v25
    s_lshl_b32 s35, s34, 8
    s_add_u32 s35, s35, 131072
    v_lshl_add_u32 v159, v1, 2, s35
    ds_write_b32 v159, v24
    s_mov_b64 exec, s[96:97]
    s_cbranch_execz L_not0r
    v_xor_b32 v36, s90, v36
    v_xor_b32 v37, s91, v37
    v_xor_b32 v38, s92, v38
    v_xor_b32 v39, s93, v39
    v_or3_b32 v35, v36, v37, v38
    v_or_b32 v35, v35, v39
    v_and_b32 v35, 0x3ff, v35
    v_sub_u32 v36, s98, v36
    v_cmp_eq_u32 vcc, 0, v35
    s_nop 1
    v_cndmask_b32 v36, 0, v36, vcc
    v_max_i32 v36, 0, v36
    v_min_i32 v36, 204800, v36
    s_nop 1
    v_max_i32_dpp v36, v36, v36 quad_perm:[1,0,3,2] row_mask:0xf bank_mask:0xf
    s_nop 1
    v_max_i32_dpp v36, v36, v36 quad_perm:[2,3,0,1] row_mask:0xf bank_mask:0xf
    s_nop 1
    v_max_i32_dpp v36, v36, v36 row_half_mirror row_mask:0xf bank_mask:0xf
    v_lshrrev_b32 v36, 13, v36
    s_mov_b64 exec, 1
    ds_write_b32 v164, v36 offset:36
L_not0r:
    s_mov_b64 exec, -1
    s_mov_b64 exec, 1
    v_mov_b32 v156, 1
    s_waitcnt lgkmcnt(0)
    ds_add_u32 v164, v156 offset:0
    s_mov_b64 exec, -1
    s_mov_b32 s49, 0
Lspin_195:
    ds_read_b32 v156, v164 offset:28
    s_waitcnt lgkmcnt(0)
    v_readfirstlane_b32 s50, v156
    s_nop 0
    s_cmp_eq_u32 s50, 4
    s_cbranch_scc1 Lspun_196
    s_sleep 1
    s_add_u32 s49, s49, 1
    s_cmp_lt_u32 s49, 4194304
    s_cbranch_scc1 Lspin_195
Lspun_196:
    v_lshrrev_b32 v156, 3, v1
    v_and_b32 v157, 3, v156
    v_lshrrev_b32 v156, 2, v156
    v_lshlrev_b32 v156, 10, v156
    v_lshl_add_u32 v156, v157, 17, v156
    v_and_b32 v157, 7, v1
    v_lshl_add_u32 v160, v157, 4, v156
    s_lshl_b32 s53, s94, 19
    s_lshl_b32 s54, s95, 15
    s_add_u32 s53, s53, s54
    s_lshl_b32 s54, s101, 7
    s_add_u32 s53, s53, s54
    s_lshl_b32 s54, s34, 13
    s_add_u32 s53, s53, s54
    s_mov_b32 s35, s53
    s_waitcnt vmcnt(0)
    s_setprio 0
    v_mov_b32 v56, 0xbdd2d3e8
    v_mov_b32 v76, 0xc0135761
    v_mov_b32 v78, 1.0
    v_lshlrev_b32 v82, 16, v82
    v_lshlrev_b32 v96, 16, v96
    v_lshlrev_b32 v110, 16, v110
    v_lshlrev_b32 v84, 16, v84
    v_lshlrev_b32 v98, 16, v98
    v_lshlrev_b32 v112, 16, v112
    v_lshlrev_b32 v86, 16, v86
    v_lshlrev_b32 v100, 16, v100
    v_lshlrev_b32 v114, 16, v114
    v_lshlrev_b32 v88, 16, v88
    v_lshlrev_b32 v102, 16, v102
    v_lshlrev_b32 v116, 16, v116
    v_lshlrev_b32 v90, 16, v90
    v_lshlrev_b32 v104, 16, v104
    v_lshlrev_b32 v118, 16, v118
    v_lshlrev_b32 v92, 16, v92
    v_lshlrev_b32 v106, 16, v106
    v_lshlrev_b32 v120, 16, v120
    v_lshlrev_b32 v94, 16, v94
    v_lshlrev_b32 v108, 16, v108
    v_lshlrev_b32 v122, 16, v122
    s_lshl_b32 s53, s2, 20
    s_add_u32 s53, s53, 838860800
    s_add_u32 s58, s53, 0
    s_or_b32 s59, s58, 0x80000000
    s_add_u32 s60, s53, 65536
    s_or_b32 s61, s60, 0x80000000
    s_add_u32 s62, s53, 131072
    s_or_b32 s63, s62, 0x80000000
    s_add_u32 s64, s53, 196608
    s_or_b32 s65, s64, 0x80000000
    s_add_u32 s66, s53, 262144
    s_or_b32 s67, s66, 0x80000000
    s_add_u32 s68, s53, 327680
    s_or_b32 s69, s68, 0x80000000
    s_add_u32 s70, s53, 393216
    s_or_b32 s71, s70, 0x80000000
    s_add_u32 s72, s53, 458752
    s_or_b32 s73, s72, 0x80000000
    s_add_u32 s74, s53, 524288
    s_or_b32 s75, s74, 0x80000000
    s_add_u32 s76, s53, 589824
    s_or_b32 s77, s76, 0x80000000
    s_add_u32 s78, s53, 655360
    s_or_b32 s79, s78, 0x80000000
    s_add_u32 s80, s53, 720896
    s_or_b32 s81, s80, 0x80000000
    s_add_u32 s82, s53, 786432
    s_or_b32 s83, s82, 0x80000000
    s_add_u32 s84, s53, 851968
    s_or_b32 s85, s84, 0x80000000
    s_add_u32 s86, s53, 917504
    s_or_b32 s87, s86, 0x80000000
    s_add_u32 s88, s53, 983040
    s_or_b32 s89, s88, 0x80000000
    s_cmp_eq_u32 s2, 0
    s_cselect_b32 s58, 0, s58
    s_cselect_b32 s59, 0, s59
    s_lshl_b32 s57, s34, 12
    s_add_u32 s57, s57, 147456
    s_add_u32 m0, s57, 0
    s_nop 0
    buffer_load_dwordx4 v160, s[24:27], s35 offen nt lds
    v_pk_fma_f32 v[58:59], s[58:59], v[82:83], v[96:97] op_sel:[0,0,0] op_sel_hi:[1,0,0]
    v_pk_fma_f32 v[62:63], s[60:61], v[82:83], v[96:97] op_sel:[0,0,0] op_sel_hi:[1,0,0]
    v_pk_fma_f32 v[66:67], s[62:63], v[82:83], v[96:97] op_sel:[0,0,0] op_sel_hi:[1,0,0]
    v_pk_fma_f32 v[70:71], s[64:65], v[82:83], v[96:97] op_sel:[0,0,0] op_sel_hi:[1,0,0]
    v_pk_mul_f32 v[60:61], v[58:59], v[58:59] op_sel:[0,0] op_sel_hi:[1,1]
    v_pk_mul_f32 v[64:65], v[62:63], v[62:63] op_sel:[0,0] op_sel_hi:[1,1]
    v_pk_mul_f32 v[68:69], v[66:67], v[66:67] op_sel:[0,0] op_sel_hi:[1,1]
    v_pk_mul_f32 v[72:73], v[70:71], v[70:71] op_sel:[0,0] op_sel_hi:[1,1]
    v_pk_fma_f32 v[60:61], v[60:61], v[56:57], v[76:77] op_sel:[0,0,0] op_sel_hi:[1,0,0]
    v_pk_fma_f32 v[64:65], v[64:65], v[56:57], v[76:77] op_sel:[0,0,0] op_sel_hi:[1,0,0]
    v_pk_fma_f32 v[68:69], v[68:69], v[56:57], v[76:77] op_sel:[0,0,0] op_sel_hi:[1,0,0]
    v_pk_fma_f32 v[72:73], v[72:73], v[56:57], v[76:77] op_sel:[0,0,0] op_sel_hi:[1,0,0]
    v_pk_mul_f32 v[60:61], v[60:61], v[58:59] op_sel:[0,0] op_sel_hi:[1,1]
    v_pk_mul_f32 v[64:65], v[64:65], v[62:63] op_sel:[0,0] op_sel_hi:[1,1]
    v_pk_mul_f32 v[68:69], v[68:69], v[66:67] op_sel:[0,0] op_sel_hi:[1,1]
    v_pk_mul_f32 v[72:73], v[72:73], v[70:71] op_sel:[0,0] op_sel_hi:[1,1]
    v_exp_f32 v60, v60
    v_exp_f32 v61, v61
    v_pk_mul_f32 v[58:59], v[58:59], v[110:111] op_sel:[0,0] op_sel_hi:[1,0]
    v_exp_f32 v64, v64
    v_exp_f32 v65, v65
    v_pk_mul_f32 v[62:63], v[62:63], v[110:111] op_sel:[0,0] op_sel_hi:[1,0]
    v_exp_f32 v68, v68
    v_exp_f32 v69, v69
    v_pk_mul_f32 v[66:67], v[66:67], v[110:111] op_sel:[0,0] op_sel_hi:[1,0]
    v_exp_f32 v72, v72
    v_exp_f32 v73, v73
    v_pk_mul_f32 v[70:71], v[70:71], v[110:111] op_sel:[0,0] op_sel_hi:[1,0]
    v_pk_add_f32 v[60:61], v[60:61], v[78:79] op_sel:[0,0] op_sel_hi:[1,0]
    v_pk_add_f32 v[64:65], v[64:65], v[78:79] op_sel:[0,0] op_sel_hi:[1,0]
    v_pk_add_f32 v[68:69], v[68:69], v[78:79] op_sel:[0,0] op_sel_hi:[1,0]
    v_pk_add_f32 v[72:73], v[72:73], v[78:79] op_sel:[0,0] op_sel_hi:[1,0]
    v_rcp_f32 v60, v60
    v_rcp_f32 v61, v61
    v_rcp_f32 v64, v64
    v_rcp_f32 v65, v65
    v_rcp_f32 v68, v68
    v_rcp_f32 v69, v69
    v_rcp_f32 v72, v72
    v_rcp_f32 v73, v73
    v_pk_mul_f32 v[124:125], v[58:59], v[60:61] op_sel:[0,0] op_sel_hi:[1,1]
    v_pk_mul_f32 v[126:127], v[62:63], v[64:65] op_sel:[0,0] op_sel_hi:[1,1]
    v_pk_mul_f32 v[128:129], v[66:67], v[68:69] op_sel:[0,0] op_sel_hi:[1,1]
    v_pk_mul_f32 v[130:131], v[70:71], v[72:73] op_sel:[0,0] op_sel_hi:[1,1]
    v_pk_fma_f32 v[58:59], s[66:67], v[82:83], v[96:97] op_sel:[0,0,0] op_sel_hi:[1,0,0]
    v_pk_fma_f32 v[62:63], s[68:69], v[82:83], v[96:97] op_sel:[0,0,0] op_sel_hi:[1,0,0]
    v_pk_fma_f32 v[66:67], s[70:71], v[82:83], v[96:97] op_sel:[0,0,0] op_sel_hi:[1,0,0]
    v_pk_fma_f32 v[70:71], s[72:73], v[82:83], v[96:97] op_sel:[0,0,0] op_sel_hi:[1,0,0]
    v_pk_mul_f32 v[60:61], v[58:59], v[58:59] op_sel:[0,0] op_sel_hi:[1,1]
    v_pk_mul_f32 v[64:65], v[62:63], v[62:63] op_sel:[0,0] op_sel_hi:[1,1]
    v_pk_mul_f32 v[68:69], v[66:67], v[66:67] op_sel:[0,0] op_sel_hi:[1,1]
    v_pk_mul_f32 v[72:73], v[70:71], v[70:71] op_sel:[0,0] op_sel_hi:[1,1]
    v_pk_fma_f32 v[60:61], v[60:61], v[56:57], v[76:77] op_sel:[0,0,0] op_sel_hi:[1,0,0]
    v_pk_fma_f32 v[64:65], v[64:65], v[56:57], v[76:77] op_sel:[0,0,0] op_sel_hi:[1,0,0]
    v_pk_fma_f32 v[68:69], v[68:69], v[56:57], v[76:77] op_sel:[0,0,0] op_sel_hi:[1,0,0]
    v_pk_fma_f32 v[72:73], v[72:73], v[56:57], v[76:77] op_sel:[0,0,0] op_sel_hi:[1,0,0]
    v_pk_mul_f32 v[60:61], v[60:61], v[58:59] op_sel:[0,0] op_sel_hi:[1,1]
    v_pk_mul_f32 v[64:65], v[64:65], v[62:63] op_sel:[0,0] op_sel_hi:[1,1]
    v_pk_mul_f32 v[68:69], v[68:69], v[66:67] op_sel:[0,0] op_sel_hi:[1,1]
    v_pk_mul_f32 v[72:73], v[72:73], v[70:71] op_sel:[0,0] op_sel_hi:[1,1]
    v_exp_f32 v60, v60
    v_exp_f32 v61, v61
    v_pk_mul_f32 v[58:59], v[58:59], v[110:111] op_sel:[0,0] op_sel_hi:[1,0]
    v_exp_f32 v64, v64
    v_exp_f32 v65, v65
    v_pk_mul_f32 v[62:63], v[62:63], v[110:111] op_sel:[0,0] op_sel_hi:[1,0]
    v_exp_f32 v68, v68
    v_exp_f32 v69, v69
    v_pk_mul_f32 v[66:67], v[66:67], v[110:111] op_sel:[0,0] op_sel_hi:[1,0]
    v_exp_f32 v72, v72
    v_exp_f32 v73, v73
    v_pk_mul_f32 v[70:71], v[70:71], v[110:111] op_sel:[0,0] op_sel_hi:[1,0]
    v_pk_add_f32 v[60:61], v[60:61], v[78:79] op_sel:[0,0] op_sel_hi:[1,0]
    v_pk_add_f32 v[64:65], v[64:65], v[78:79] op_sel:[0,0] op_sel_hi:[1,0]
    v_pk_add_f32 v[68:69], v[68:69], v[78:79] op_sel:[0,0] op_sel_hi:[1,0]
    v_pk_add_f32 v[72:73], v[72:73], v[78:79] op_sel:[0,0] op_sel_hi:[1,0]
    v_rcp_f32 v60, v60
    v_rcp_f32 v61, v61
    v_rcp_f32 v64, v64
    v_rcp_f32 v65, v65
    v_rcp_f32 v68, v68
    v_rcp_f32 v69, v69
    v_rcp_f32 v72, v72
    v_rcp_f32 v73, v73
    v_pk_mul_f32 v[132:133], v[58:59], v[60:61] op_sel:[0,0] op_sel_hi:[1,1]
    v_pk_mul_f32 v[134:135], v[62:63], v[64:65] op_sel:[0,0] op_sel_hi:[1,1]
    v_pk_mul_f32 v[136:137], v[66:67], v[68:69] op_sel:[0,0] op_sel_hi:[1,1]
    v_pk_mul_f32 v[138:139], v[70:71], v[72:73] op_sel:[0,0] op_sel_hi:[1,1]
    v_pk_fma_f32 v[58:59], s[74:75], v[82:83], v[96:97] op_sel:[0,0,0] op_sel_hi:[1,0,0]
    v_pk_fma_f32 v[62:63], s[76:77], v[82:83], v[96:97] op_sel:[0,0,0] op_sel_hi:[1,0,0]
    v_pk_fma_f32 v[66:67], s[78:79], v[82:83], v[96:97] op_sel:[0,0,0] op_sel_hi:[1,0,0]
    v_pk_fma_f32 v[70:71], s[80:81], v[82:83], v[96:97] op_sel:[0,0,0] op_sel_hi:[1,0,0]
    v_pk_mul_f32 v[60:61], v[58:59], v[58:59] op_sel:[0,0] op_sel_hi:[1,1]
    v_pk_mul_f32 v[64:65], v[62:63], v[62:63] op_sel:[0,0] op_sel_hi:[1,1]
    v_pk_mul_f32 v[68:69], v[66:67], v[66:67] op_sel:[0,0] op_sel_hi:[1,1]
    v_pk_mul_f32 v[72:73], v[70:71], v[70:71] op_sel:[0,0] op_sel_hi:[1,1]
    v_pk_fma_f32 v[60:61], v[60:61], v[56:57], v[76:77] op_sel:[0,0,0] op_sel_hi:[1,0,0]
    v_pk_fma_f32 v[64:65], v[64:65], v[56:57], v[76:77] op_sel:[0,0,0] op_sel_hi:[1,0,0]
    v_pk_fma_f32 v[68:69], v[68:69], v[56:57], v[76:77] op_sel:[0,0,0] op_sel_hi:[1,0,0]
    v_pk_fma_f32 v[72:73], v[72:73], v[56:57], v[76:77] op_sel:[0,0,0] op_sel_hi:[1,0,0]
    v_pk_mul_f32 v[60:61], v[60:61], v[58:59] op_sel:[0,0] op_sel_hi:[1,1]
    v_pk_mul_f32 v[64:65], v[64:65], v[62:63] op_sel:[0,0] op_sel_hi:[1,1]
    v_pk_mul_f32 v[68:69], v[68:69], v[66:67] op_sel:[0,0] op_sel_hi:[1,1]
    v_pk_mul_f32 v[72:73], v[72:73], v[70:71] op_sel:[0,0] op_sel_hi:[1,1]
    v_exp_f32 v60, v60
    v_exp_f32 v61, v61
    v_pk_mul_f32 v[58:59], v[58:59], v[110:111] op_sel:[0,0] op_sel_hi:[1,0]
    v_exp_f32 v64, v64
    v_exp_f32 v65, v65
    v_pk_mul_f32 v[62:63], v[62:63], v[110:111] op_sel:[0,0] op_sel_hi:[1,0]
    v_exp_f32 v68, v68
    v_exp_f32 v69, v69
    v_pk_mul_f32 v[66:67], v[66:67], v[110:111] op_sel:[0,0] op_sel_hi:[1,0]
    v_exp_f32 v72, v72
    v_exp_f32 v73, v73
    v_pk_mul_f32 v[70:71], v[70:71], v[110:111] op_sel:[0,0] op_sel_hi:[1,0]
    v_pk_add_f32 v[60:61], v[60:61], v[78:79] op_sel:[0,0] op_sel_hi:[1,0]
    v_pk_add_f32 v[64:65], v[64:65], v[78:79] op_sel:[0,0] op_sel_hi:[1,0]
    v_pk_add_f32 v[68:69], v[68:69], v[78:79] op_sel:[0,0] op_sel_hi:[1,0]
    v_pk_add_f32 v[72:73], v[72:73], v[78:79] op_sel:[0,0] op_sel_hi:[1,0]
    v_rcp_f32 v60, v60
    v_rcp_f32 v61, v61
    v_rcp_f32 v64, v64
    v_rcp_f32 v65, v65
    v_rcp_f32 v68, v68
    v_rcp_f32 v69, v69
    v_rcp_f32 v72, v72
    v_rcp_f32 v73, v73
    v_pk_mul_f32 v[140:141], v[58:59], v[60:61] op_sel:[0,0] op_sel_hi:[1,1]
    v_pk_mul_f32 v[142:143], v[62:63], v[64:65] op_sel:[0,0] op_sel_hi:[1,1]
    v_pk_mul_f32 v[144:145], v[66:67], v[68:69] op_sel:[0,0] op_sel_hi:[1,1]
    v_pk_mul_f32 v[146:147], v[70:71], v[72:73] op_sel:[0,0] op_sel_hi:[1,1]
    v_pk_fma_f32 v[58:59], s[82:83], v[82:83], v[96:97] op_sel:[0,0,0] op_sel_hi:[1,0,0]
    v_pk_fma_f32 v[62:63], s[84:85], v[82:83], v[96:97] op_sel:[0,0,0] op_sel_hi:[1,0,0]
    v_pk_fma_f32 v[66:67], s[86:87], v[82:83], v[96:97] op_sel:[0,0,0] op_sel_hi:[1,0,0]
    v_pk_fma_f32 v[70:71], s[88:89], v[82:83], v[96:97] op_sel:[0,0,0] op_sel_hi:[1,0,0]
    v_pk_mul_f32 v[60:61], v[58:59], v[58:59] op_sel:[0,0] op_sel_hi:[1,1]
    v_pk_mul_f32 v[64:65], v[62:63], v[62:63] op_sel:[0,0] op_sel_hi:[1,1]
    v_pk_mul_f32 v[68:69], v[66:67], v[66:67] op_sel:[0,0] op_sel_hi:[1,1]
    v_pk_mul_f32 v[72:73], v[70:71], v[70:71] op_sel:[0,0] op_sel_hi:[1,1]
    v_pk_fma_f32 v[60:61], v[60:61], v[56:57], v[76:77] op_sel:[0,0,0] op_sel_hi:[1,0,0]
    v_pk_fma_f32 v[64:65], v[64:65], v[56:57], v[76:77] op_sel:[0,0,0] op_sel_hi:[1,0,0]
    v_pk_fma_f32 v[68:69], v[68:69], v[56:57], v[76:77] op_sel:[0,0,0] op_sel_hi:[1,0,0]
    v_pk_fma_f32 v[72:73], v[72:73], v[56:57], v[76:77] op_sel:[0,0,0] op_sel_hi:[1,0,0]
    v_pk_mul_f32 v[60:61], v[60:61], v[58:59] op_sel:[0,0] op_sel_hi:[1,1]
    v_pk_mul_f32 v[64:65], v[64:65], v[62:63] op_sel:[0,0] op_sel_hi:[1,1]
    v_pk_mul_f32 v[68:69], v[68:69], v[66:67] op_sel:[0,0] op_sel_hi:[1,1]
    v_pk_mul_f32 v[72:73], v[72:73], v[70:71] op_sel:[0,0] op_sel_hi:[1,1]
    v_exp_f32 v60, v60
    v_exp_f32 v61, v61
    v_pk_mul_f32 v[58:59], v[58:59], v[110:111] op_sel:[0,0] op_sel_hi:[1,0]
    v_exp_f32 v64, v64
    v_exp_f32 v65, v65
    v_pk_mul_f32 v[62:63], v[62:63], v[110:111] op_sel:[0,0] op_sel_hi:[1,0]
    v_exp_f32 v68, v68
    v_exp_f32 v69, v69
    v_pk_mul_f32 v[66:67], v[66:67], v[110:111] op_sel:[0,0] op_sel_hi:[1,0]
    v_exp_f32 v72, v72
    v_exp_f32 v73, v73
    v_pk_mul_f32 v[70:71], v[70:71], v[110:111] op_sel:[0,0] op_sel_hi:[1,0]
    v_pk_add_f32 v[60:61], v[60:61], v[78:79] op_sel:[0,0] op_sel_hi:[1,0]
    v_pk_add_f32 v[64:65], v[64:65], v[78:79] op_sel:[0,0] op_sel_hi:[1,0]
    v_pk_add_f32 v[68:69], v[68:69], v[78:79] op_sel:[0,0] op_sel_hi:[1,0]
    v_pk_add_f32 v[72:73], v[72:73], v[78:79] op_sel:[0,0] op_sel_hi:[1,0]
    v_rcp_f32 v60, v60
    v_rcp_f32 v61, v61
    v_rcp_f32 v64, v64
    v_rcp_f32 v65, v65
    v_rcp_f32 v68, v68
    v_rcp_f32 v69, v69
    v_rcp_f32 v72, v72
    v_rcp_f32 v73, v73
    v_pk_mul_f32 v[148:149], v[58:59], v[60:61] op_sel:[0,0] op_sel_hi:[1,1]
    v_pk_mul_f32 v[150:151], v[62:63], v[64:65] op_sel:[0,0] op_sel_hi:[1,1]
    v_pk_mul_f32 v[152:153], v[66:67], v[68:69] op_sel:[0,0] op_sel_hi:[1,1]
    v_pk_mul_f32 v[154:155], v[70:71], v[72:73] op_sel:[0,0] op_sel_hi:[1,1]
    v_pk_fma_f32 v[58:59], s[58:59], v[84:85], v[98:99] op_sel:[0,0,0] op_sel_hi:[1,0,0]
    v_pk_fma_f32 v[62:63], s[60:61], v[84:85], v[98:99] op_sel:[0,0,0] op_sel_hi:[1,0,0]
    v_pk_fma_f32 v[66:67], s[62:63], v[84:85], v[98:99] op_sel:[0,0,0] op_sel_hi:[1,0,0]
    v_pk_fma_f32 v[70:71], s[64:65], v[84:85], v[98:99] op_sel:[0,0,0] op_sel_hi:[1,0,0]
    v_pk_mul_f32 v[60:61], v[58:59], v[58:59] op_sel:[0,0] op_sel_hi:[1,1]
    v_pk_mul_f32 v[64:65], v[62:63], v[62:63] op_sel:[0,0] op_sel_hi:[1,1]
    v_pk_mul_f32 v[68:69], v[66:67], v[66:67] op_sel:[0,0] op_sel_hi:[1,1]
    v_pk_mul_f32 v[72:73], v[70:71], v[70:71] op_sel:[0,0] op_sel_hi:[1,1]
    v_pk_fma_f32 v[60:61], v[60:61], v[56:57], v[76:77] op_sel:[0,0,0] op_sel_hi:[1,0,0]
    v_pk_fma_f32 v[64:65], v[64:65], v[56:57], v[76:77] op_sel:[0,0,0] op_sel_hi:[1,0,0]
    v_pk_fma_f32 v[68:69], v[68:69], v[56:57], v[76:77] op_sel:[0,0,0] op_sel_hi:[1,0,0]
    v_pk_fma_f32 v[72:73], v[72:73], v[56:57], v[76:77] op_sel:[0,0,0] op_sel_hi:[1,0,0]
    v_pk_mul_f32 v[60:61], v[60:61], v[58:59] op_sel:[0,0] op_sel_hi:[1,1]
    v_pk_mul_f32 v[64:65], v[64:65], v[62:63] op_sel:[0,0] op_sel_hi:[1,1]
    v_pk_mul_f32 v[68:69], v[68:69], v[66:67] op_sel:[0,0] op_sel_hi:[1,1]
    v_pk_mul_f32 v[72:73], v[72:73], v[70:71] op_sel:[0,0] op_sel_hi:[1,1]
    v_exp_f32 v60, v60
    v_exp_f32 v61, v61
    v_pk_mul_f32 v[58:59], v[58:59], v[112:113] op_sel:[0,0] op_sel_hi:[1,0]
    v_exp_f32 v64, v64
    v_exp_f32 v65, v65
    v_pk_mul_f32 v[62:63], v[62:63], v[112:113] op_sel:[0,0] op_sel_hi:[1,0]
    v_exp_f32 v68, v68
    v_exp_f32 v69, v69
    v_pk_mul_f32 v[66:67], v[66:67], v[112:113] op_sel:[0,0] op_sel_hi:[1,0]
    v_exp_f32 v72, v72
    v_exp_f32 v73, v73
    v_pk_mul_f32 v[70:71], v[70:71], v[112:113] op_sel:[0,0] op_sel_hi:[1,0]
    v_pk_add_f32 v[60:61], v[60:61], v[78:79] op_sel:[0,0] op_sel_hi:[1,0]
    v_pk_add_f32 v[64:65], v[64:65], v[78:79] op_sel:[0,0] op_sel_hi:[1,0]
    v_pk_add_f32 v[68:69], v[68:69], v[78:79] op_sel:[0,0] op_sel_hi:[1,0]
    v_pk_add_f32 v[72:73], v[72:73], v[78:79] op_sel:[0,0] op_sel_hi:[1,0]
    v_rcp_f32 v60, v60
    v_rcp_f32 v61, v61
    v_rcp_f32 v64, v64
    v_rcp_f32 v65, v65
    v_rcp_f32 v68, v68
    v_rcp_f32 v69, v69
    v_rcp_f32 v72, v72
    v_rcp_f32 v73, v73
    v_pk_fma_f32 v[124:125], v[58:59], v[60:61], v[124:125] op_sel:[0,0,0] op_sel_hi:[1,1,1]
    v_pk_fma_f32 v[126:127], v[62:63], v[64:65], v[126:127] op_sel:[0,0,0] op_sel_hi:[1,1,1]
    v_pk_fma_f32 v[128:129], v[66:67], v[68:69], v[128:129] op_sel:[0,0,0] op_sel_hi:[1,1,1]
    v_pk_fma_f32 v[130:131], v[70:71], v[72:73], v[130:131] op_sel:[0,0,0] op_sel_hi:[1,1,1]
    v_pk_fma_f32 v[58:59], s[66:67], v[84:85], v[98:99] op_sel:[0,0,0] op_sel_hi:[1,0,0]
    v_pk_fma_f32 v[62:63], s[68:69], v[84:85], v[98:99] op_sel:[0,0,0] op_sel_hi:[1,0,0]
    v_pk_fma_f32 v[66:67], s[70:71], v[84:85], v[98:99] op_sel:[0,0,0] op_sel_hi:[1,0,0]
    v_pk_fma_f32 v[70:71], s[72:73], v[84:85], v[98:99] op_sel:[0,0,0] op_sel_hi:[1,0,0]
    v_pk_mul_f32 v[60:61], v[58:59], v[58:59] op_sel:[0,0] op_sel_hi:[1,1]
    v_pk_mul_f32 v[64:65], v[62:63], v[62:63] op_sel:[0,0] op_sel_hi:[1,1]
    v_pk_mul_f32 v[68:69], v[66:67], v[66:67] op_sel:[0,0] op_sel_hi:[1,1]
    v_pk_mul_f32 v[72:73], v[70:71], v[70:71] op_sel:[0,0] op_sel_hi:[1,1]
    v_pk_fma_f32 v[60:61], v[60:61], v[56:57], v[76:77] op_sel:[0,0,0] op_sel_hi:[1,0,0]
    v_pk_fma_f32 v[64:65], v[64:65], v[56:57], v[76:77] op_sel:[0,0,0] op_sel_hi:[1,0,0]
    v_pk_fma_f32 v[68:69], v[68:69], v[56:57], v[76:77] op_sel:[0,0,0] op_sel_hi:[1,0,0]
    v_pk_fma_f32 v[72:73], v[72:73], v[56:57], v[76:77] op_sel:[0,0,0] op_sel_hi:[1,0,0]
    v_pk_mul_f32 v[60:61], v[60:61], v[58:59] op_sel:[0,0] op_sel_hi:[1,1]
    v_pk_mul_f32 v[64:65], v[64:65], v[62:63] op_sel:[0,0] op_sel_hi:[1,1]
    v_pk_mul_f32 v[68:69], v[68:69], v[66:67] op_sel:[0,0] op_sel_hi:[1,1]
    v_pk_mul_f32 v[72:73], v[72:73], v[70:71] op_sel:[0,0] op_sel_hi:[1,1]
    v_exp_f32 v60, v60
    v_exp_f32 v61, v61
    v_pk_mul_f32 v[58:59], v[58:59], v[112:113] op_sel:[0,0] op_sel_hi:[1,0]
    v_exp_f32 v64, v64
    v_exp_f32 v65, v65
    v_pk_mul_f32 v[62:63], v[62:63], v[112:113] op_sel:[0,0] op_sel_hi:[1,0]
    v_exp_f32 v68, v68
    v_exp_f32 v69, v69
    v_pk_mul_f32 v[66:67], v[66:67], v[112:113] op_sel:[0,0] op_sel_hi:[1,0]
    v_exp_f32 v72, v72
    v_exp_f32 v73, v73
    v_pk_mul_f32 v[70:71], v[70:71], v[112:113] op_sel:[0,0] op_sel_hi:[1,0]
    v_pk_add_f32 v[60:61], v[60:61], v[78:79] op_sel:[0,0] op_sel_hi:[1,0]
    v_pk_add_f32 v[64:65], v[64:65], v[78:79] op_sel:[0,0] op_sel_hi:[1,0]
    v_pk_add_f32 v[68:69], v[68:69], v[78:79] op_sel:[0,0] op_sel_hi:[1,0]
    v_pk_add_f32 v[72:73], v[72:73], v[78:79] op_sel:[0,0] op_sel_hi:[1,0]
    v_rcp_f32 v60, v60
    v_rcp_f32 v61, v61
    v_rcp_f32 v64, v64
    v_rcp_f32 v65, v65
    v_rcp_f32 v68, v68
    v_rcp_f32 v69, v69
    v_rcp_f32 v72, v72
    v_rcp_f32 v73, v73
    v_pk_fma_f32 v[132:133], v[58:59], v[60:61], v[132:133] op_sel:[0,0,0] op_sel_hi:[1,1,1]
    v_pk_fma_f32 v[134:135], v[62:63], v[64:65], v[134:135] op_sel:[0,0,0] op_sel_hi:[1,1,1]
    v_pk_fma_f32 v[136:137], v[66:67], v[68:69], v[136:137] op_sel:[0,0,0] op_sel_hi:[1,1,1]
    v_pk_fma_f32 v[138:139], v[70:71], v[72:73], v[138:139] op_sel:[0,0,0] op_sel_hi:[1,1,1]
    v_pk_fma_f32 v[58:59], s[74:75], v[84:85], v[98:99] op_sel:[0,0,0] op_sel_hi:[1,0,0]
    v_pk_fma_f32 v[62:63], s[76:77], v[84:85], v[98:99] op_sel:[0,0,0] op_sel_hi:[1,0,0]
    v_pk_fma_f32 v[66:67], s[78:79], v[84:85], v[98:99] op_sel:[0,0,0] op_sel_hi:[1,0,0]
    v_pk_fma_f32 v[70:71], s[80:81], v[84:85], v[98:99] op_sel:[0,0,0] op_sel_hi:[1,0,0]
    v_pk_mul_f32 v[60:61], v[58:59], v[58:59] op_sel:[0,0] op_sel_hi:[1,1]
    v_pk_mul_f32 v[64:65], v[62:63], v[62:63] op_sel:[0,0] op_sel_hi:[1,1]
    v_pk_mul_f32 v[68:69], v[66:67], v[66:67] op_sel:[0,0] op_sel_hi:[1,1]
    v_pk_mul_f32 v[72:73], v[70:71], v[70:71] op_sel:[0,0] op_sel_hi:[1,1]
    v_pk_fma_f32 v[60:61], v[60:61], v[56:57], v[76:77] op_sel:[0,0,0] op_sel_hi:[1,0,0]
    v_pk_fma_f32 v[64:65], v[64:65], v[56:57], v[76:77] op_sel:[0,0,0] op_sel_hi:[1,0,0]
    v_pk_fma_f32 v[68:69], v[68:69], v[56:57], v[76:77] op_sel:[0,0,0] op_sel_hi:[1,0,0]
    v_pk_fma_f32 v[72:73], v[72:73], v[56:57], v[76:77] op_sel:[0,0,0] op_sel_hi:[1,0,0]
    v_pk_mul_f32 v[60:61], v[60:61], v[58:59] op_sel:[0,0] op_sel_hi:[1,1]
    v_pk_mul_f32 v[64:65], v[64:65], v[62:63] op_sel:[0,0] op_sel_hi:[1,1]
    v_pk_mul_f32 v[68:69], v[68:69], v[66:67] op_sel:[0,0] op_sel_hi:[1,1]
    v_pk_mul_f32 v[72:73], v[72:73], v[70:71] op_sel:[0,0] op_sel_hi:[1,1]
    v_exp_f32 v60, v60
    v_exp_f32 v61, v61
    v_pk_mul_f32 v[58:59], v[58:59], v[112:113] op_sel:[0,0] op_sel_hi:[1,0]
    v_exp_f32 v64, v64
    v_exp_f32 v65, v65
    v_pk_mul_f32 v[62:63], v[62:63], v[112:113] op_sel:[0,0] op_sel_hi:[1,0]
    v_exp_f32 v68, v68
    v_exp_f32 v69, v69
    v_pk_mul_f32 v[66:67], v[66:67], v[112:113] op_sel:[0,0] op_sel_hi:[1,0]
    v_exp_f32 v72, v72
    v_exp_f32 v73, v73
    v_pk_mul_f32 v[70:71], v[70:71], v[112:113] op_sel:[0,0] op_sel_hi:[1,0]
    v_pk_add_f32 v[60:61], v[60:61], v[78:79] op_sel:[0,0] op_sel_hi:[1,0]
    v_pk_add_f32 v[64:65], v[64:65], v[78:79] op_sel:[0,0] op_sel_hi:[1,0]
    v_pk_add_f32 v[68:69], v[68:69], v[78:79] op_sel:[0,0] op_sel_hi:[1,0]
    v_pk_add_f32 v[72:73], v[72:73], v[78:79] op_sel:[0,0] op_sel_hi:[1,0]
    v_rcp_f32 v60, v60
    v_rcp_f32 v61, v61
    v_rcp_f32 v64, v64
    v_rcp_f32 v65, v65
    v_rcp_f32 v68, v68
    v_rcp_f32 v69, v69
    v_rcp_f32 v72, v72
    v_rcp_f32 v73, v73
    v_pk_fma_f32 v[140:141], v[58:59], v[60:61], v[140:141] op_sel:[0,0,0] op_sel_hi:[1,1,1]
    v_pk_fma_f32 v[142:143], v[62:63], v[64:65], v[142:143] op_sel:[0,0,0] op_sel_hi:[1,1,1]
    v_pk_fma_f32 v[144:145], v[66:67], v[68:69], v[144:145] op_sel:[0,0,0] op_sel_hi:[1,1,1]
    v_pk_fma_f32 v[146:147], v[70:71], v[72:73], v[146:147] op_sel:[0,0,0] op_sel_hi:[1,1,1]
    v_pk_fma_f32 v[58:59], s[82:83], v[84:85], v[98:99] op_sel:[0,0,0] op_sel_hi:[1,0,0]
    v_pk_fma_f32 v[62:63], s[84:85], v[84:85], v[98:99] op_sel:[0,0,0] op_sel_hi:[1,0,0]
    v_pk_fma_f32 v[66:67], s[86:87], v[84:85], v[98:99] op_sel:[0,0,0] op_sel_hi:[1,0,0]
    v_pk_fma_f32 v[70:71], s[88:89], v[84:85], v[98:99] op_sel:[0,0,0] op_sel_hi:[1,0,0]
    v_pk_mul_f32 v[60:61], v[58:59], v[58:59] op_sel:[0,0] op_sel_hi:[1,1]
    v_pk_mul_f32 v[64:65], v[62:63], v[62:63] op_sel:[0,0] op_sel_hi:[1,1]
    v_pk_mul_f32 v[68:69], v[66:67], v[66:67] op_sel:[0,0] op_sel_hi:[1,1]
    v_pk_mul_f32 v[72:73], v[70:71], v[70:71] op_sel:[0,0] op_sel_hi:[1,1]
    v_pk_fma_f32 v[60:61], v[60:61], v[56:57], v[76:77] op_sel:[0,0,0] op_sel_hi:[1,0,0]
    v_pk_fma_f32 v[64:65], v[64:65], v[56:57], v[76:77] op_sel:[0,0,0] op_sel_hi:[1,0,0]
    v_pk_fma_f32 v[68:69], v[68:69], v[56:57], v[76:77] op_sel:[0,0,0] op_sel_hi:[1,0,0]
    v_pk_fma_f32 v[72:73], v[72:73], v[56:57], v[76:77] op_sel:[0,0,0] op_sel_hi:[1,0,0]
    v_pk_mul_f32 v[60:61], v[60:61], v[58:59] op_sel:[0,0] op_sel_hi:[1,1]
    v_pk_mul_f32 v[64:65], v[64:65], v[62:63] op_sel:[0,0] op_sel_hi:[1,1]
    v_pk_mul_f32 v[68:69], v[68:69], v[66:67] op_sel:[0,0] op_sel_hi:[1,1]
    v_pk_mul_f32 v[72:73], v[72:73], v[70:71] op_sel:[0,0] op_sel_hi:[1,1]
    v_exp_f32 v60, v60
    v_exp_f32 v61, v61
    v_pk_mul_f32 v[58:59], v[58:59], v[112:113] op_sel:[0,0] op_sel_hi:[1,0]
    v_exp_f32 v64, v64
    v_exp_f32 v65, v65
    v_pk_mul_f32 v[62:63], v[62:63], v[112:113] op_sel:[0,0] op_sel_hi:[1,0]
    v_exp_f32 v68, v68
    v_exp_f32 v69, v69
    v_pk_mul_f32 v[66:67], v[66:67], v[112:113] op_sel:[0,0] op_sel_hi:[1,0]
    v_exp_f32 v72, v72
    v_exp_f32 v73, v73
    v_pk_mul_f32 v[70:71], v[70:71], v[112:113] op_sel:[0,0] op_sel_hi:[1,0]
    v_pk_add_f32 v[60:61], v[60:61], v[78:79] op_sel:[0,0] op_sel_hi:[1,0]
    v_pk_add_f32 v[64:65], v[64:65], v[78:79] op_sel:[0,0] op_sel_hi:[1,0]
    v_pk_add_f32 v[68:69], v[68:69], v[78:79] op_sel:[0,0] op_sel_hi:[1,0]
    v_pk_add_f32 v[72:73], v[72:73], v[78:79] op_sel:[0,0] op_sel_hi:[1,0]
    v_rcp_f32 v60, v60
    v_rcp_f32 v61, v61
    v_rcp_f32 v64, v64
    v_rcp_f32 v65, v65
    v_rcp_f32 v68, v68
    v_rcp_f32 v69, v69
    v_rcp_f32 v72, v72
    v_rcp_f32 v73, v73
    v_pk_fma_f32 v[148:149], v[58:59], v[60:61], v[148:149] op_sel:[0,0,0] op_sel_hi:[1,1,1]
    v_pk_fma_f32 v[150:151], v[62:63], v[64:65], v[150:151] op_sel:[0,0,0] op_sel_hi:[1,1,1]
    v_pk_fma_f32 v[152:153], v[66:67], v[68:69], v[152:153] op_sel:[0,0,0] op_sel_hi:[1,1,1]
    v_pk_fma_f32 v[154:155], v[70:71], v[72:73], v[154:155] op_sel:[0,0,0] op_sel_hi:[1,1,1]
    s_lshl_b32 s57, s34, 12
    s_add_u32 s57, s57, 147456
    s_add_u32 m0, s57, 1024
    v_xor_b32 v156, 32, v160
    s_add_u32 s56, s35, 2048
    buffer_load_dwordx4 v156, s[24:27], s56 offen nt lds
    v_pk_fma_f32 v[58:59], s[58:59], v[86:87], v[100:101] op_sel:[0,0,0] op_sel_hi:[1,0,0]
    v_pk_fma_f32 v[62:63], s[60:61], v[86:87], v[100:101] op_sel:[0,0,0] op_sel_hi:[1,0,0]
    v_pk_fma_f32 v[66:67], s[62:63], v[86:87], v[100:101] op_sel:[0,0,0] op_sel_hi:[1,0,0]
    v_pk_fma_f32 v[70:71], s[64:65], v[86:87], v[100:101] op_sel:[0,0,0] op_sel_hi:[1,0,0]
    v_pk_mul_f32 v[60:61], v[58:59], v[58:59] op_sel:[0,0] op_sel_hi:[1,1]
    v_pk_mul_f32 v[64:65], v[62:63], v[62:63] op_sel:[0,0] op_sel_hi:[1,1]
    v_pk_mul_f32 v[68:69], v[66:67], v[66:67] op_sel:[0,0] op_sel_hi:[1,1]
    v_pk_mul_f32 v[72:73], v[70:71], v[70:71] op_sel:[0,0] op_sel_hi:[1,1]
    v_pk_fma_f32 v[60:61], v[60:61], v[56:57], v[76:77] op_sel:[0,0,0] op_sel_hi:[1,0,0]
    v_pk_fma_f32 v[64:65], v[64:65], v[56:57], v[76:77] op_sel:[0,0,0] op_sel_hi:[1,0,0]
    v_pk_fma_f32 v[68:69], v[68:69], v[56:57], v[76:77] op_sel:[0,0,0] op_sel_hi:[1,0,0]
    v_pk_fma_f32 v[72:73], v[72:73], v[56:57], v[76:77] op_sel:[0,0,0] op_sel_hi:[1,0,0]
    v_pk_mul_f32 v[60:61], v[60:61], v[58:59] op_sel:[0,0] op_sel_hi:[1,1]
    v_pk_mul_f32 v[64:65], v[64:65], v[62:63] op_sel:[0,0] op_sel_hi:[1,1]
    v_pk_mul_f32 v[68:69], v[68:69], v[66:67] op_sel:[0,0] op_sel_hi:[1,1]
    v_pk_mul_f32 v[72:73], v[72:73], v[70:71] op_sel:[0,0] op_sel_hi:[1,1]
    v_exp_f32 v60, v60
    v_exp_f32 v61, v61
    v_pk_mul_f32 v[58:59], v[58:59], v[114:115] op_sel:[0,0] op_sel_hi:[1,0]
    v_exp_f32 v64, v64
    v_exp_f32 v65, v65
    v_pk_mul_f32 v[62:63], v[62:63], v[114:115] op_sel:[0,0] op_sel_hi:[1,0]
    v_exp_f32 v68, v68
    v_exp_f32 v69, v69
    v_pk_mul_f32 v[66:67], v[66:67], v[114:115] op_sel:[0,0] op_sel_hi:[1,0]
    v_exp_f32 v72, v72
    v_exp_f32 v73, v73
    v_pk_mul_f32 v[70:71], v[70:71], v[114:115] op_sel:[0,0] op_sel_hi:[1,0]
    v_pk_add_f32 v[60:61], v[60:61], v[78:79] op_sel:[0,0] op_sel_hi:[1,0]
    v_pk_add_f32 v[64:65], v[64:65], v[78:79] op_sel:[0,0] op_sel_hi:[1,0]
    v_pk_add_f32 v[68:69], v[68:69], v[78:79] op_sel:[0,0] op_sel_hi:[1,0]
    v_pk_add_f32 v[72:73], v[72:73], v[78:79] op_sel:[0,0] op_sel_hi:[1,0]
    v_rcp_f32 v60, v60
    v_rcp_f32 v61, v61
    v_rcp_f32 v64, v64
    v_rcp_f32 v65, v65
    v_rcp_f32 v68, v68
    v_rcp_f32 v69, v69
    v_rcp_f32 v72, v72
    v_rcp_f32 v73, v73
    v_pk_fma_f32 v[124:125], v[58:59], v[60:61], v[124:125] op_sel:[0,0,0] op_sel_hi:[1,1,1]
    v_pk_fma_f32 v[126:127], v[62:63], v[64:65], v[126:127] op_sel:[0,0,0] op_sel_hi:[1,1,1]
    v_pk_fma_f32 v[128:129], v[66:67], v[68:69], v[128:129] op_sel:[0,0,0] op_sel_hi:[1,1,1]
    v_pk_fma_f32 v[130:131], v[70:71], v[72:73], v[130:131] op_sel:[0,0,0] op_sel_hi:[1,1,1]
    v_pk_fma_f32 v[58:59], s[66:67], v[86:87], v[100:101] op_sel:[0,0,0] op_sel_hi:[1,0,0]
    v_pk_fma_f32 v[62:63], s[68:69], v[86:87], v[100:101] op_sel:[0,0,0] op_sel_hi:[1,0,0]
    v_pk_fma_f32 v[66:67], s[70:71], v[86:87], v[100:101] op_sel:[0,0,0] op_sel_hi:[1,0,0]
    v_pk_fma_f32 v[70:71], s[72:73], v[86:87], v[100:101] op_sel:[0,0,0] op_sel_hi:[1,0,0]
    v_pk_mul_f32 v[60:61], v[58:59], v[58:59] op_sel:[0,0] op_sel_hi:[1,1]
    v_pk_mul_f32 v[64:65], v[62:63], v[62:63] op_sel:[0,0] op_sel_hi:[1,1]
    v_pk_mul_f32 v[68:69], v[66:67], v[66:67] op_sel:[0,0] op_sel_hi:[1,1]
    v_pk_mul_f32 v[72:73], v[70:71], v[70:71] op_sel:[0,0] op_sel_hi:[1,1]
    v_pk_fma_f32 v[60:61], v[60:61], v[56:57], v[76:77] op_sel:[0,0,0] op_sel_hi:[1,0,0]
    v_pk_fma_f32 v[64:65], v[64:65], v[56:57], v[76:77] op_sel:[0,0,0] op_sel_hi:[1,0,0]
    v_pk_fma_f32 v[68:69], v[68:69], v[56:57], v[76:77] op_sel:[0,0,0] op_sel_hi:[1,0,0]
    v_pk_fma_f32 v[72:73], v[72:73], v[56:57], v[76:77] op_sel:[0,0,0] op_sel_hi:[1,0,0]
    v_pk_mul_f32 v[60:61], v[60:61], v[58:59] op_sel:[0,0] op_sel_hi:[1,1]
    v_pk_mul_f32 v[64:65], v[64:65], v[62:63] op_sel:[0,0] op_sel_hi:[1,1]
    v_pk_mul_f32 v[68:69], v[68:69], v[66:67] op_sel:[0,0] op_sel_hi:[1,1]
    v_pk_mul_f32 v[72:73], v[72:73], v[70:71] op_sel:[0,0] op_sel_hi:[1,1]
    v_exp_f32 v60, v60
    v_exp_f32 v61, v61
    v_pk_mul_f32 v[58:59], v[58:59], v[114:115] op_sel:[0,0] op_sel_hi:[1,0]
    v_exp_f32 v64, v64
    v_exp_f32 v65, v65
    v_pk_mul_f32 v[62:63], v[62:63], v[114:115] op_sel:[0,0] op_sel_hi:[1,0]
    v_exp_f32 v68, v68
    v_exp_f32 v69, v69
    v_pk_mul_f32 v[66:67], v[66:67], v[114:115] op_sel:[0,0] op_sel_hi:[1,0]
    v_exp_f32 v72, v72
    v_exp_f32 v73, v73
    v_pk_mul_f32 v[70:71], v[70:71], v[114:115] op_sel:[0,0] op_sel_hi:[1,0]
    v_pk_add_f32 v[60:61], v[60:61], v[78:79] op_sel:[0,0] op_sel_hi:[1,0]
    v_pk_add_f32 v[64:65], v[64:65], v[78:79] op_sel:[0,0] op_sel_hi:[1,0]
    v_pk_add_f32 v[68:69], v[68:69], v[78:79] op_sel:[0,0] op_sel_hi:[1,0]
    v_pk_add_f32 v[72:73], v[72:73], v[78:79] op_sel:[0,0] op_sel_hi:[1,0]
    v_rcp_f32 v60, v60
    v_rcp_f32 v61, v61
    v_rcp_f32 v64, v64
    v_rcp_f32 v65, v65
    v_rcp_f32 v68, v68
    v_rcp_f32 v69, v69
    v_rcp_f32 v72, v72
    v_rcp_f32 v73, v73
    v_pk_fma_f32 v[132:133], v[58:59], v[60:61], v[132:133] op_sel:[0,0,0] op_sel_hi:[1,1,1]
    v_pk_fma_f32 v[134:135], v[62:63], v[64:65], v[134:135] op_sel:[0,0,0] op_sel_hi:[1,1,1]
    v_pk_fma_f32 v[136:137], v[66:67], v[68:69], v[136:137] op_sel:[0,0,0] op_sel_hi:[1,1,1]
    v_pk_fma_f32 v[138:139], v[70:71], v[72:73], v[138:139] op_sel:[0,0,0] op_sel_hi:[1,1,1]
    v_pk_fma_f32 v[58:59], s[74:75], v[86:87], v[100:101] op_sel:[0,0,0] op_sel_hi:[1,0,0]
    v_pk_fma_f32 v[62:63], s[76:77], v[86:87], v[100:101] op_sel:[0,0,0] op_sel_hi:[1,0,0]
    v_pk_fma_f32 v[66:67], s[78:79], v[86:87], v[100:101] op_sel:[0,0,0] op_sel_hi:[1,0,0]
    v_pk_fma_f32 v[70:71], s[80:81], v[86:87], v[100:101] op_sel:[0,0,0] op_sel_hi:[1,0,0]
    v_pk_mul_f32 v[60:61], v[58:59], v[58:59] op_sel:[0,0] op_sel_hi:[1,1]
    v_pk_mul_f32 v[64:65], v[62:63], v[62:63] op_sel:[0,0] op_sel_hi:[1,1]
    v_pk_mul_f32 v[68:69], v[66:67], v[66:67] op_sel:[0,0] op_sel_hi:[1,1]
    v_pk_mul_f32 v[72:73], v[70:71], v[70:71] op_sel:[0,0] op_sel_hi:[1,1]
    v_pk_fma_f32 v[60:61], v[60:61], v[56:57], v[76:77] op_sel:[0,0,0] op_sel_hi:[1,0,0]
    v_pk_fma_f32 v[64:65], v[64:65], v[56:57], v[76:77] op_sel:[0,0,0] op_sel_hi:[1,0,0]
    v_pk_fma_f32 v[68:69], v[68:69], v[56:57], v[76:77] op_sel:[0,0,0] op_sel_hi:[1,0,0]
    v_pk_fma_f32 v[72:73], v[72:73], v[56:57], v[76:77] op_sel:[0,0,0] op_sel_hi:[1,0,0]
    v_pk_mul_f32 v[60:61], v[60:61], v[58:59] op_sel:[0,0] op_sel_hi:[1,1]
    v_pk_mul_f32 v[64:65], v[64:65], v[62:63] op_sel:[0,0] op_sel_hi:[1,1]
    v_pk_mul_f32 v[68:69], v[68:69], v[66:67] op_sel:[0,0] op_sel_hi:[1,1]
    v_pk_mul_f32 v[72:73], v[72:73], v[70:71] op_sel:[0,0] op_sel_hi:[1,1]
    v_exp_f32 v60, v60
    v_exp_f32 v61, v61
    v_pk_mul_f32 v[58:59], v[58:59], v[114:115] op_sel:[0,0] op_sel_hi:[1,0]
    v_exp_f32 v64, v64
    v_exp_f32 v65, v65
    v_pk_mul_f32 v[62:63], v[62:63], v[114:115] op_sel:[0,0] op_sel_hi:[1,0]
    v_exp_f32 v68, v68
    v_exp_f32 v69, v69
    v_pk_mul_f32 v[66:67], v[66:67], v[114:115] op_sel:[0,0] op_sel_hi:[1,0]
    v_exp_f32 v72, v72
    v_exp_f32 v73, v73
    v_pk_mul_f32 v[70:71], v[70:71], v[114:115] op_sel:[0,0] op_sel_hi:[1,0]
    v_pk_add_f32 v[60:61], v[60:61], v[78:79] op_sel:[0,0] op_sel_hi:[1,0]
    v_pk_add_f32 v[64:65], v[64:65], v[78:79] op_sel:[0,0] op_sel_hi:[1,0]
    v_pk_add_f32 v[68:69], v[68:69], v[78:79] op_sel:[0,0] op_sel_hi:[1,0]
    v_pk_add_f32 v[72:73], v[72:73], v[78:79] op_sel:[0,0] op_sel_hi:[1,0]
    v_rcp_f32 v60, v60
    v_rcp_f32 v61, v61
    v_rcp_f32 v64, v64
    v_rcp_f32 v65, v65
    v_rcp_f32 v68, v68
    v_rcp_f32 v69, v69
    v_rcp_f32 v72, v72
    v_rcp_f32 v73, v73
    v_pk_fma_f32 v[140:141], v[58:59], v[60:61], v[140:141] op_sel:[0,0,0] op_sel_hi:[1,1,1]
    v_pk_fma_f32 v[142:143], v[62:63], v[64:65], v[142:143] op_sel:[0,0,0] op_sel_hi:[1,1,1]
    v_pk_fma_f32 v[144:145], v[66:67], v[68:69], v[144:145] op_sel:[0,0,0] op_sel_hi:[1,1,1]
    v_pk_fma_f32 v[146:147], v[70:71], v[72:73], v[146:147] op_sel:[0,0,0] op_sel_hi:[1,1,1]
    v_pk_fma_f32 v[58:59], s[82:83], v[86:87], v[100:101] op_sel:[0,0,0] op_sel_hi:[1,0,0]
    v_pk_fma_f32 v[62:63], s[84:85], v[86:87], v[100:101] op_sel:[0,0,0] op_sel_hi:[1,0,0]
    v_pk_fma_f32 v[66:67], s[86:87], v[86:87], v[100:101] op_sel:[0,0,0] op_sel_hi:[1,0,0]
    v_pk_fma_f32 v[70:71], s[88:89], v[86:87], v[100:101] op_sel:[0,0,0] op_sel_hi:[1,0,0]
    v_pk_mul_f32 v[60:61], v[58:59], v[58:59] op_sel:[0,0] op_sel_hi:[1,1]
    v_pk_mul_f32 v[64:65], v[62:63], v[62:63] op_sel:[0,0] op_sel_hi:[1,1]
    v_pk_mul_f32 v[68:69], v[66:67], v[66:67] op_sel:[0,0] op_sel_hi:[1,1]
    v_pk_mul_f32 v[72:73], v[70:71], v[70:71] op_sel:[0,0] op_sel_hi:[1,1]
    v_pk_fma_f32 v[60:61], v[60:61], v[56:57], v[76:77] op_sel:[0,0,0] op_sel_hi:[1,0,0]
    v_pk_fma_f32 v[64:65], v[64:65], v[56:57], v[76:77] op_sel:[0,0,0] op_sel_hi:[1,0,0]
    v_pk_fma_f32 v[68:69], v[68:69], v[56:57], v[76:77] op_sel:[0,0,0] op_sel_hi:[1,0,0]
    v_pk_fma_f32 v[72:73], v[72:73], v[56:57], v[76:77] op_sel:[0,0,0] op_sel_hi:[1,0,0]
    v_pk_mul_f32 v[60:61], v[60:61], v[58:59] op_sel:[0,0] op_sel_hi:[1,1]
    v_pk_mul_f32 v[64:65], v[64:65], v[62:63] op_sel:[0,0] op_sel_hi:[1,1]
    v_pk_mul_f32 v[68:69], v[68:69], v[66:67] op_sel:[0,0] op_sel_hi:[1,1]
    v_pk_mul_f32 v[72:73], v[72:73], v[70:71] op_sel:[0,0] op_sel_hi:[1,1]
    v_exp_f32 v60, v60
    v_exp_f32 v61, v61
    v_pk_mul_f32 v[58:59], v[58:59], v[114:115] op_sel:[0,0] op_sel_hi:[1,0]
    v_exp_f32 v64, v64
    v_exp_f32 v65, v65
    v_pk_mul_f32 v[62:63], v[62:63], v[114:115] op_sel:[0,0] op_sel_hi:[1,0]
    v_exp_f32 v68, v68
    v_exp_f32 v69, v69
    v_pk_mul_f32 v[66:67], v[66:67], v[114:115] op_sel:[0,0] op_sel_hi:[1,0]
    v_exp_f32 v72, v72
    v_exp_f32 v73, v73
    v_pk_mul_f32 v[70:71], v[70:71], v[114:115] op_sel:[0,0] op_sel_hi:[1,0]
    v_pk_add_f32 v[60:61], v[60:61], v[78:79] op_sel:[0,0] op_sel_hi:[1,0]
    v_pk_add_f32 v[64:65], v[64:65], v[78:79] op_sel:[0,0] op_sel_hi:[1,0]
    v_pk_add_f32 v[68:69], v[68:69], v[78:79] op_sel:[0,0] op_sel_hi:[1,0]
    v_pk_add_f32 v[72:73], v[72:73], v[78:79] op_sel:[0,0] op_sel_hi:[1,0]
    v_rcp_f32 v60, v60
    v_rcp_f32 v61, v61
    v_rcp_f32 v64, v64
    v_rcp_f32 v65, v65
    v_rcp_f32 v68, v68
    v_rcp_f32 v69, v69
    v_rcp_f32 v72, v72
    v_rcp_f32 v73, v73
    v_pk_fma_f32 v[148:149], v[58:59], v[60:61], v[148:149] op_sel:[0,0,0] op_sel_hi:[1,1,1]
    v_pk_fma_f32 v[150:151], v[62:63], v[64:65], v[150:151] op_sel:[0,0,0] op_sel_hi:[1,1,1]
    v_pk_fma_f32 v[152:153], v[66:67], v[68:69], v[152:153] op_sel:[0,0,0] op_sel_hi:[1,1,1]
    v_pk_fma_f32 v[154:155], v[70:71], v[72:73], v[154:155] op_sel:[0,0,0] op_sel_hi:[1,1,1]
    v_pk_fma_f32 v[58:59], s[58:59], v[88:89], v[102:103] op_sel:[0,0,0] op_sel_hi:[1,0,0]
    v_pk_fma_f32 v[62:63], s[60:61], v[88:89], v[102:103] op_sel:[0,0,0] op_sel_hi:[1,0,0]
    v_pk_fma_f32 v[66:67], s[62:63], v[88:89], v[102:103] op_sel:[0,0,0] op_sel_hi:[1,0,0]
    v_pk_fma_f32 v[70:71], s[64:65], v[88:89], v[102:103] op_sel:[0,0,0] op_sel_hi:[1,0,0]
    v_pk_mul_f32 v[60:61], v[58:59], v[58:59] op_sel:[0,0] op_sel_hi:[1,1]
    v_pk_mul_f32 v[64:65], v[62:63], v[62:63] op_sel:[0,0] op_sel_hi:[1,1]
    v_pk_mul_f32 v[68:69], v[66:67], v[66:67] op_sel:[0,0] op_sel_hi:[1,1]
    v_pk_mul_f32 v[72:73], v[70:71], v[70:71] op_sel:[0,0] op_sel_hi:[1,1]
    v_pk_fma_f32 v[60:61], v[60:61], v[56:57], v[76:77] op_sel:[0,0,0] op_sel_hi:[1,0,0]
    v_pk_fma_f32 v[64:65], v[64:65], v[56:57], v[76:77] op_sel:[0,0,0] op_sel_hi:[1,0,0]
    v_pk_fma_f32 v[68:69], v[68:69], v[56:57], v[76:77] op_sel:[0,0,0] op_sel_hi:[1,0,0]
    v_pk_fma_f32 v[72:73], v[72:73], v[56:57], v[76:77] op_sel:[0,0,0] op_sel_hi:[1,0,0]
    v_pk_mul_f32 v[60:61], v[60:61], v[58:59] op_sel:[0,0] op_sel_hi:[1,1]
    v_pk_mul_f32 v[64:65], v[64:65], v[62:63] op_sel:[0,0] op_sel_hi:[1,1]
    v_pk_mul_f32 v[68:69], v[68:69], v[66:67] op_sel:[0,0] op_sel_hi:[1,1]
    v_pk_mul_f32 v[72:73], v[72:73], v[70:71] op_sel:[0,0] op_sel_hi:[1,1]
    v_exp_f32 v60, v60
    v_exp_f32 v61, v61
    v_pk_mul_f32 v[58:59], v[58:59], v[116:117] op_sel:[0,0] op_sel_hi:[1,0]
    v_exp_f32 v64, v64
    v_exp_f32 v65, v65
    v_pk_mul_f32 v[62:63], v[62:63], v[116:117] op_sel:[0,0] op_sel_hi:[1,0]
    v_exp_f32 v68, v68
    v_exp_f32 v69, v69
    v_pk_mul_f32 v[66:67], v[66:67], v[116:117] op_sel:[0,0] op_sel_hi:[1,0]
    v_exp_f32 v72, v72
    v_exp_f32 v73, v73
    v_pk_mul_f32 v[70:71], v[70:71], v[116:117] op_sel:[0,0] op_sel_hi:[1,0]
    v_pk_add_f32 v[60:61], v[60:61], v[78:79] op_sel:[0,0] op_sel_hi:[1,0]
    v_pk_add_f32 v[64:65], v[64:65], v[78:79] op_sel:[0,0] op_sel_hi:[1,0]
    v_pk_add_f32 v[68:69], v[68:69], v[78:79] op_sel:[0,0] op_sel_hi:[1,0]
    v_pk_add_f32 v[72:73], v[72:73], v[78:79] op_sel:[0,0] op_sel_hi:[1,0]
    v_rcp_f32 v60, v60
    v_rcp_f32 v61, v61
    v_rcp_f32 v64, v64
    v_rcp_f32 v65, v65
    v_rcp_f32 v68, v68
    v_rcp_f32 v69, v69
    v_rcp_f32 v72, v72
    v_rcp_f32 v73, v73
    v_pk_fma_f32 v[124:125], v[58:59], v[60:61], v[124:125] op_sel:[0,0,0] op_sel_hi:[1,1,1]
    v_pk_fma_f32 v[126:127], v[62:63], v[64:65], v[126:127] op_sel:[0,0,0] op_sel_hi:[1,1,1]
    v_pk_fma_f32 v[128:129], v[66:67], v[68:69], v[128:129] op_sel:[0,0,0] op_sel_hi:[1,1,1]
    v_pk_fma_f32 v[130:131], v[70:71], v[72:73], v[130:131] op_sel:[0,0,0] op_sel_hi:[1,1,1]
    v_pk_fma_f32 v[58:59], s[66:67], v[88:89], v[102:103] op_sel:[0,0,0] op_sel_hi:[1,0,0]
    v_pk_fma_f32 v[62:63], s[68:69], v[88:89], v[102:103] op_sel:[0,0,0] op_sel_hi:[1,0,0]
    v_pk_fma_f32 v[66:67], s[70:71], v[88:89], v[102:103] op_sel:[0,0,0] op_sel_hi:[1,0,0]
    v_pk_fma_f32 v[70:71], s[72:73], v[88:89], v[102:103] op_sel:[0,0,0] op_sel_hi:[1,0,0]
    v_pk_mul_f32 v[60:61], v[58:59], v[58:59] op_sel:[0,0] op_sel_hi:[1,1]
    v_pk_mul_f32 v[64:65], v[62:63], v[62:63] op_sel:[0,0] op_sel_hi:[1,1]
    v_pk_mul_f32 v[68:69], v[66:67], v[66:67] op_sel:[0,0] op_sel_hi:[1,1]
    v_pk_mul_f32 v[72:73], v[70:71], v[70:71] op_sel:[0,0] op_sel_hi:[1,1]
    v_pk_fma_f32 v[60:61], v[60:61], v[56:57], v[76:77] op_sel:[0,0,0] op_sel_hi:[1,0,0]
    v_pk_fma_f32 v[64:65], v[64:65], v[56:57], v[76:77] op_sel:[0,0,0] op_sel_hi:[1,0,0]
    v_pk_fma_f32 v[68:69], v[68:69], v[56:57], v[76:77] op_sel:[0,0,0] op_sel_hi:[1,0,0]
    v_pk_fma_f32 v[72:73], v[72:73], v[56:57], v[76:77] op_sel:[0,0,0] op_sel_hi:[1,0,0]
    v_pk_mul_f32 v[60:61], v[60:61], v[58:59] op_sel:[0,0] op_sel_hi:[1,1]
    v_pk_mul_f32 v[64:65], v[64:65], v[62:63] op_sel:[0,0] op_sel_hi:[1,1]
    v_pk_mul_f32 v[68:69], v[68:69], v[66:67] op_sel:[0,0] op_sel_hi:[1,1]
    v_pk_mul_f32 v[72:73], v[72:73], v[70:71] op_sel:[0,0] op_sel_hi:[1,1]
    v_exp_f32 v60, v60
    v_exp_f32 v61, v61
    v_pk_mul_f32 v[58:59], v[58:59], v[116:117] op_sel:[0,0] op_sel_hi:[1,0]
    v_exp_f32 v64, v64
    v_exp_f32 v65, v65
    v_pk_mul_f32 v[62:63], v[62:63], v[116:117] op_sel:[0,0] op_sel_hi:[1,0]
    v_exp_f32 v68, v68
    v_exp_f32 v69, v69
    v_pk_mul_f32 v[66:67], v[66:67], v[116:117] op_sel:[0,0] op_sel_hi:[1,0]
    v_exp_f32 v72, v72
    v_exp_f32 v73, v73
    v_pk_mul_f32 v[70:71], v[70:71], v[116:117] op_sel:[0,0] op_sel_hi:[1,0]
    v_pk_add_f32 v[60:61], v[60:61], v[78:79] op_sel:[0,0] op_sel_hi:[1,0]
    v_pk_add_f32 v[64:65], v[64:65], v[78:79] op_sel:[0,0] op_sel_hi:[1,0]
    v_pk_add_f32 v[68:69], v[68:69], v[78:79] op_sel:[0,0] op_sel_hi:[1,0]
    v_pk_add_f32 v[72:73], v[72:73], v[78:79] op_sel:[0,0] op_sel_hi:[1,0]
    v_rcp_f32 v60, v60
    v_rcp_f32 v61, v61
    v_rcp_f32 v64, v64
    v_rcp_f32 v65, v65
    v_rcp_f32 v68, v68
    v_rcp_f32 v69, v69
    v_rcp_f32 v72, v72
    v_rcp_f32 v73, v73
    v_pk_fma_f32 v[132:133], v[58:59], v[60:61], v[132:133] op_sel:[0,0,0] op_sel_hi:[1,1,1]
    v_pk_fma_f32 v[134:135], v[62:63], v[64:65], v[134:135] op_sel:[0,0,0] op_sel_hi:[1,1,1]
    v_pk_fma_f32 v[136:137], v[66:67], v[68:69], v[136:137] op_sel:[0,0,0] op_sel_hi:[1,1,1]
    v_pk_fma_f32 v[138:139], v[70:71], v[72:73], v[138:139] op_sel:[0,0,0] op_sel_hi:[1,1,1]
    v_pk_fma_f32 v[58:59], s[74:75], v[88:89], v[102:103] op_sel:[0,0,0] op_sel_hi:[1,0,0]
    v_pk_fma_f32 v[62:63], s[76:77], v[88:89], v[102:103] op_sel:[0,0,0] op_sel_hi:[1,0,0]
    v_pk_fma_f32 v[66:67], s[78:79], v[88:89], v[102:103] op_sel:[0,0,0] op_sel_hi:[1,0,0]
    v_pk_fma_f32 v[70:71], s[80:81], v[88:89], v[102:103] op_sel:[0,0,0] op_sel_hi:[1,0,0]
    v_pk_mul_f32 v[60:61], v[58:59], v[58:59] op_sel:[0,0] op_sel_hi:[1,1]
    v_pk_mul_f32 v[64:65], v[62:63], v[62:63] op_sel:[0,0] op_sel_hi:[1,1]
    v_pk_mul_f32 v[68:69], v[66:67], v[66:67] op_sel:[0,0] op_sel_hi:[1,1]
    v_pk_mul_f32 v[72:73], v[70:71], v[70:71] op_sel:[0,0] op_sel_hi:[1,1]
    v_pk_fma_f32 v[60:61], v[60:61], v[56:57], v[76:77] op_sel:[0,0,0] op_sel_hi:[1,0,0]
    v_pk_fma_f32 v[64:65], v[64:65], v[56:57], v[76:77] op_sel:[0,0,0] op_sel_hi:[1,0,0]
    v_pk_fma_f32 v[68:69], v[68:69], v[56:57], v[76:77] op_sel:[0,0,0] op_sel_hi:[1,0,0]
    v_pk_fma_f32 v[72:73], v[72:73], v[56:57], v[76:77] op_sel:[0,0,0] op_sel_hi:[1,0,0]
    v_pk_mul_f32 v[60:61], v[60:61], v[58:59] op_sel:[0,0] op_sel_hi:[1,1]
    v_pk_mul_f32 v[64:65], v[64:65], v[62:63] op_sel:[0,0] op_sel_hi:[1,1]
    v_pk_mul_f32 v[68:69], v[68:69], v[66:67] op_sel:[0,0] op_sel_hi:[1,1]
    v_pk_mul_f32 v[72:73], v[72:73], v[70:71] op_sel:[0,0] op_sel_hi:[1,1]
    v_exp_f32 v60, v60
    v_exp_f32 v61, v61
    v_pk_mul_f32 v[58:59], v[58:59], v[116:117] op_sel:[0,0] op_sel_hi:[1,0]
    v_exp_f32 v64, v64
    v_exp_f32 v65, v65
    v_pk_mul_f32 v[62:63], v[62:63], v[116:117] op_sel:[0,0] op_sel_hi:[1,0]
    v_exp_f32 v68, v68
    v_exp_f32 v69, v69
    v_pk_mul_f32 v[66:67], v[66:67], v[116:117] op_sel:[0,0] op_sel_hi:[1,0]
    v_exp_f32 v72, v72
    v_exp_f32 v73, v73
    v_pk_mul_f32 v[70:71], v[70:71], v[116:117] op_sel:[0,0] op_sel_hi:[1,0]
    v_pk_add_f32 v[60:61], v[60:61], v[78:79] op_sel:[0,0] op_sel_hi:[1,0]
    v_pk_add_f32 v[64:65], v[64:65], v[78:79] op_sel:[0,0] op_sel_hi:[1,0]
    v_pk_add_f32 v[68:69], v[68:69], v[78:79] op_sel:[0,0] op_sel_hi:[1,0]
    v_pk_add_f32 v[72:73], v[72:73], v[78:79] op_sel:[0,0] op_sel_hi:[1,0]
    v_rcp_f32 v60, v60
    v_rcp_f32 v61, v61
    v_rcp_f32 v64, v64
    v_rcp_f32 v65, v65
    v_rcp_f32 v68, v68
    v_rcp_f32 v69, v69
    v_rcp_f32 v72, v72
    v_rcp_f32 v73, v73
    v_pk_fma_f32 v[140:141], v[58:59], v[60:61], v[140:141] op_sel:[0,0,0] op_sel_hi:[1,1,1]
    v_pk_fma_f32 v[142:143], v[62:63], v[64:65], v[142:143] op_sel:[0,0,0] op_sel_hi:[1,1,1]
    v_pk_fma_f32 v[144:145], v[66:67], v[68:69], v[144:145] op_sel:[0,0,0] op_sel_hi:[1,1,1]
    v_pk_fma_f32 v[146:147], v[70:71], v[72:73], v[146:147] op_sel:[0,0,0] op_sel_hi:[1,1,1]
    v_pk_fma_f32 v[58:59], s[82:83], v[88:89], v[102:103] op_sel:[0,0,0] op_sel_hi:[1,0,0]
    v_pk_fma_f32 v[62:63], s[84:85], v[88:89], v[102:103] op_sel:[0,0,0] op_sel_hi:[1,0,0]
    v_pk_fma_f32 v[66:67], s[86:87], v[88:89], v[102:103] op_sel:[0,0,0] op_sel_hi:[1,0,0]
    v_pk_fma_f32 v[70:71], s[88:89], v[88:89], v[102:103] op_sel:[0,0,0] op_sel_hi:[1,0,0]
    v_pk_mul_f32 v[60:61], v[58:59], v[58:59] op_sel:[0,0] op_sel_hi:[1,1]
    v_pk_mul_f32 v[64:65], v[62:63], v[62:63] op_sel:[0,0] op_sel_hi:[1,1]
    v_pk_mul_f32 v[68:69], v[66:67], v[66:67] op_sel:[0,0] op_sel_hi:[1,1]
    v_pk_mul_f32 v[72:73], v[70:71], v[70:71] op_sel:[0,0] op_sel_hi:[1,1]
    v_pk_fma_f32 v[60:61], v[60:61], v[56:57], v[76:77] op_sel:[0,0,0] op_sel_hi:[1,0,0]
    v_pk_fma_f32 v[64:65], v[64:65], v[56:57], v[76:77] op_sel:[0,0,0] op_sel_hi:[1,0,0]
    v_pk_fma_f32 v[68:69], v[68:69], v[56:57], v[76:77] op_sel:[0,0,0] op_sel_hi:[1,0,0]
    v_pk_fma_f32 v[72:73], v[72:73], v[56:57], v[76:77] op_sel:[0,0,0] op_sel_hi:[1,0,0]
    v_pk_mul_f32 v[60:61], v[60:61], v[58:59] op_sel:[0,0] op_sel_hi:[1,1]
    v_pk_mul_f32 v[64:65], v[64:65], v[62:63] op_sel:[0,0] op_sel_hi:[1,1]
    v_pk_mul_f32 v[68:69], v[68:69], v[66:67] op_sel:[0,0] op_sel_hi:[1,1]
    v_pk_mul_f32 v[72:73], v[72:73], v[70:71] op_sel:[0,0] op_sel_hi:[1,1]
    v_exp_f32 v60, v60
    v_exp_f32 v61, v61
    v_pk_mul_f32 v[58:59], v[58:59], v[116:117] op_sel:[0,0] op_sel_hi:[1,0]
    v_exp_f32 v64, v64
    v_exp_f32 v65, v65
    v_pk_mul_f32 v[62:63], v[62:63], v[116:117] op_sel:[0,0] op_sel_hi:[1,0]
    v_exp_f32 v68, v68
    v_exp_f32 v69, v69
    v_pk_mul_f32 v[66:67], v[66:67], v[116:117] op_sel:[0,0] op_sel_hi:[1,0]
    v_exp_f32 v72, v72
    v_exp_f32 v73, v73
    v_pk_mul_f32 v[70:71], v[70:71], v[116:117] op_sel:[0,0] op_sel_hi:[1,0]
    v_pk_add_f32 v[60:61], v[60:61], v[78:79] op_sel:[0,0] op_sel_hi:[1,0]
    v_pk_add_f32 v[64:65], v[64:65], v[78:79] op_sel:[0,0] op_sel_hi:[1,0]
    v_pk_add_f32 v[68:69], v[68:69], v[78:79] op_sel:[0,0] op_sel_hi:[1,0]
    v_pk_add_f32 v[72:73], v[72:73], v[78:79] op_sel:[0,0] op_sel_hi:[1,0]
    v_rcp_f32 v60, v60
    v_rcp_f32 v61, v61
    v_rcp_f32 v64, v64
    v_rcp_f32 v65, v65
    v_rcp_f32 v68, v68
    v_rcp_f32 v69, v69
    v_rcp_f32 v72, v72
    v_rcp_f32 v73, v73
    v_pk_fma_f32 v[148:149], v[58:59], v[60:61], v[148:149] op_sel:[0,0,0] op_sel_hi:[1,1,1]
    v_pk_fma_f32 v[150:151], v[62:63], v[64:65], v[150:151] op_sel:[0,0,0] op_sel_hi:[1,1,1]
    v_pk_fma_f32 v[152:153], v[66:67], v[68:69], v[152:153] op_sel:[0,0,0] op_sel_hi:[1,1,1]
    v_pk_fma_f32 v[154:155], v[70:71], v[72:73], v[154:155] op_sel:[0,0,0] op_sel_hi:[1,1,1]
    s_lshl_b32 s57, s34, 12
    s_add_u32 s57, s57, 147456
    s_add_u32 m0, s57, 2048
    v_xor_b32 v156, 64, v160
    s_add_u32 s56, s35, 4096
    buffer_load_dwordx4 v156, s[24:27], s56 offen nt lds
    v_pk_fma_f32 v[58:59], s[58:59], v[90:91], v[104:105] op_sel:[0,0,0] op_sel_hi:[1,0,0]
    v_pk_fma_f32 v[62:63], s[60:61], v[90:91], v[104:105] op_sel:[0,0,0] op_sel_hi:[1,0,0]
    v_pk_fma_f32 v[66:67], s[62:63], v[90:91], v[104:105] op_sel:[0,0,0] op_sel_hi:[1,0,0]
    v_pk_fma_f32 v[70:71], s[64:65], v[90:91], v[104:105] op_sel:[0,0,0] op_sel_hi:[1,0,0]
    v_pk_mul_f32 v[60:61], v[58:59], v[58:59] op_sel:[0,0] op_sel_hi:[1,1]
    v_pk_mul_f32 v[64:65], v[62:63], v[62:63] op_sel:[0,0] op_sel_hi:[1,1]
    v_pk_mul_f32 v[68:69], v[66:67], v[66:67] op_sel:[0,0] op_sel_hi:[1,1]
    v_pk_mul_f32 v[72:73], v[70:71], v[70:71] op_sel:[0,0] op_sel_hi:[1,1]
    v_pk_fma_f32 v[60:61], v[60:61], v[56:57], v[76:77] op_sel:[0,0,0] op_sel_hi:[1,0,0]
    v_pk_fma_f32 v[64:65], v[64:65], v[56:57], v[76:77] op_sel:[0,0,0] op_sel_hi:[1,0,0]
    v_pk_fma_f32 v[68:69], v[68:69], v[56:57], v[76:77] op_sel:[0,0,0] op_sel_hi:[1,0,0]
    v_pk_fma_f32 v[72:73], v[72:73], v[56:57], v[76:77] op_sel:[0,0,0] op_sel_hi:[1,0,0]
    v_pk_mul_f32 v[60:61], v[60:61], v[58:59] op_sel:[0,0] op_sel_hi:[1,1]
    v_pk_mul_f32 v[64:65], v[64:65], v[62:63] op_sel:[0,0] op_sel_hi:[1,1]
    v_pk_mul_f32 v[68:69], v[68:69], v[66:67] op_sel:[0,0] op_sel_hi:[1,1]
    v_pk_mul_f32 v[72:73], v[72:73], v[70:71] op_sel:[0,0] op_sel_hi:[1,1]
    v_exp_f32 v60, v60
    v_exp_f32 v61, v61
    v_pk_mul_f32 v[58:59], v[58:59], v[118:119] op_sel:[0,0] op_sel_hi:[1,0]
    v_exp_f32 v64, v64
    v_exp_f32 v65, v65
    v_pk_mul_f32 v[62:63], v[62:63], v[118:119] op_sel:[0,0] op_sel_hi:[1,0]
    v_exp_f32 v68, v68
    v_exp_f32 v69, v69
    v_pk_mul_f32 v[66:67], v[66:67], v[118:119] op_sel:[0,0] op_sel_hi:[1,0]
    v_exp_f32 v72, v72
    v_exp_f32 v73, v73
    v_pk_mul_f32 v[70:71], v[70:71], v[118:119] op_sel:[0,0] op_sel_hi:[1,0]
    v_pk_add_f32 v[60:61], v[60:61], v[78:79] op_sel:[0,0] op_sel_hi:[1,0]
    v_pk_add_f32 v[64:65], v[64:65], v[78:79] op_sel:[0,0] op_sel_hi:[1,0]
    v_pk_add_f32 v[68:69], v[68:69], v[78:79] op_sel:[0,0] op_sel_hi:[1,0]
    v_pk_add_f32 v[72:73], v[72:73], v[78:79] op_sel:[0,0] op_sel_hi:[1,0]
    v_rcp_f32 v60, v60
    v_rcp_f32 v61, v61
    v_rcp_f32 v64, v64
    v_rcp_f32 v65, v65
    v_rcp_f32 v68, v68
    v_rcp_f32 v69, v69
    v_rcp_f32 v72, v72
    v_rcp_f32 v73, v73
    v_pk_fma_f32 v[124:125], v[58:59], v[60:61], v[124:125] op_sel:[0,0,0] op_sel_hi:[1,1,1]
    v_pk_fma_f32 v[126:127], v[62:63], v[64:65], v[126:127] op_sel:[0,0,0] op_sel_hi:[1,1,1]
    v_pk_fma_f32 v[128:129], v[66:67], v[68:69], v[128:129] op_sel:[0,0,0] op_sel_hi:[1,1,1]
    v_pk_fma_f32 v[130:131], v[70:71], v[72:73], v[130:131] op_sel:[0,0,0] op_sel_hi:[1,1,1]
    v_pk_fma_f32 v[58:59], s[66:67], v[90:91], v[104:105] op_sel:[0,0,0] op_sel_hi:[1,0,0]
    v_pk_fma_f32 v[62:63], s[68:69], v[90:91], v[104:105] op_sel:[0,0,0] op_sel_hi:[1,0,0]
    v_pk_fma_f32 v[66:67], s[70:71], v[90:91], v[104:105] op_sel:[0,0,0] op_sel_hi:[1,0,0]
    v_pk_fma_f32 v[70:71], s[72:73], v[90:91], v[104:105] op_sel:[0,0,0] op_sel_hi:[1,0,0]
    v_pk_mul_f32 v[60:61], v[58:59], v[58:59] op_sel:[0,0] op_sel_hi:[1,1]
    v_pk_mul_f32 v[64:65], v[62:63], v[62:63] op_sel:[0,0] op_sel_hi:[1,1]
    v_pk_mul_f32 v[68:69], v[66:67], v[66:67] op_sel:[0,0] op_sel_hi:[1,1]
    v_pk_mul_f32 v[72:73], v[70:71], v[70:71] op_sel:[0,0] op_sel_hi:[1,1]
    v_pk_fma_f32 v[60:61], v[60:61], v[56:57], v[76:77] op_sel:[0,0,0] op_sel_hi:[1,0,0]
    v_pk_fma_f32 v[64:65], v[64:65], v[56:57], v[76:77] op_sel:[0,0,0] op_sel_hi:[1,0,0]
    v_pk_fma_f32 v[68:69], v[68:69], v[56:57], v[76:77] op_sel:[0,0,0] op_sel_hi:[1,0,0]
    v_pk_fma_f32 v[72:73], v[72:73], v[56:57], v[76:77] op_sel:[0,0,0] op_sel_hi:[1,0,0]
    v_pk_mul_f32 v[60:61], v[60:61], v[58:59] op_sel:[0,0] op_sel_hi:[1,1]
    v_pk_mul_f32 v[64:65], v[64:65], v[62:63] op_sel:[0,0] op_sel_hi:[1,1]
    v_pk_mul_f32 v[68:69], v[68:69], v[66:67] op_sel:[0,0] op_sel_hi:[1,1]
    v_pk_mul_f32 v[72:73], v[72:73], v[70:71] op_sel:[0,0] op_sel_hi:[1,1]
    v_exp_f32 v60, v60
    v_exp_f32 v61, v61
    v_pk_mul_f32 v[58:59], v[58:59], v[118:119] op_sel:[0,0] op_sel_hi:[1,0]
    v_exp_f32 v64, v64
    v_exp_f32 v65, v65
    v_pk_mul_f32 v[62:63], v[62:63], v[118:119] op_sel:[0,0] op_sel_hi:[1,0]
    v_exp_f32 v68, v68
    v_exp_f32 v69, v69
    v_pk_mul_f32 v[66:67], v[66:67], v[118:119] op_sel:[0,0] op_sel_hi:[1,0]
    v_exp_f32 v72, v72
    v_exp_f32 v73, v73
    v_pk_mul_f32 v[70:71], v[70:71], v[118:119] op_sel:[0,0] op_sel_hi:[1,0]
    v_pk_add_f32 v[60:61], v[60:61], v[78:79] op_sel:[0,0] op_sel_hi:[1,0]
    v_pk_add_f32 v[64:65], v[64:65], v[78:79] op_sel:[0,0] op_sel_hi:[1,0]
    v_pk_add_f32 v[68:69], v[68:69], v[78:79] op_sel:[0,0] op_sel_hi:[1,0]
    v_pk_add_f32 v[72:73], v[72:73], v[78:79] op_sel:[0,0] op_sel_hi:[1,0]
    v_rcp_f32 v60, v60
    v_rcp_f32 v61, v61
    v_rcp_f32 v64, v64
    v_rcp_f32 v65, v65
    v_rcp_f32 v68, v68
    v_rcp_f32 v69, v69
    v_rcp_f32 v72, v72
    v_rcp_f32 v73, v73
    v_pk_fma_f32 v[132:133], v[58:59], v[60:61], v[132:133] op_sel:[0,0,0] op_sel_hi:[1,1,1]
    v_pk_fma_f32 v[134:135], v[62:63], v[64:65], v[134:135] op_sel:[0,0,0] op_sel_hi:[1,1,1]
    v_pk_fma_f32 v[136:137], v[66:67], v[68:69], v[136:137] op_sel:[0,0,0] op_sel_hi:[1,1,1]
    v_pk_fma_f32 v[138:139], v[70:71], v[72:73], v[138:139] op_sel:[0,0,0] op_sel_hi:[1,1,1]
    v_pk_fma_f32 v[58:59], s[74:75], v[90:91], v[104:105] op_sel:[0,0,0] op_sel_hi:[1,0,0]
    v_pk_fma_f32 v[62:63], s[76:77], v[90:91], v[104:105] op_sel:[0,0,0] op_sel_hi:[1,0,0]
    v_pk_fma_f32 v[66:67], s[78:79], v[90:91], v[104:105] op_sel:[0,0,0] op_sel_hi:[1,0,0]
    v_pk_fma_f32 v[70:71], s[80:81], v[90:91], v[104:105] op_sel:[0,0,0] op_sel_hi:[1,0,0]
    v_pk_mul_f32 v[60:61], v[58:59], v[58:59] op_sel:[0,0] op_sel_hi:[1,1]
    v_pk_mul_f32 v[64:65], v[62:63], v[62:63] op_sel:[0,0] op_sel_hi:[1,1]
    v_pk_mul_f32 v[68:69], v[66:67], v[66:67] op_sel:[0,0] op_sel_hi:[1,1]
    v_pk_mul_f32 v[72:73], v[70:71], v[70:71] op_sel:[0,0] op_sel_hi:[1,1]
    v_pk_fma_f32 v[60:61], v[60:61], v[56:57], v[76:77] op_sel:[0,0,0] op_sel_hi:[1,0,0]
    v_pk_fma_f32 v[64:65], v[64:65], v[56:57], v[76:77] op_sel:[0,0,0] op_sel_hi:[1,0,0]
    v_pk_fma_f32 v[68:69], v[68:69], v[56:57], v[76:77] op_sel:[0,0,0] op_sel_hi:[1,0,0]
    v_pk_fma_f32 v[72:73], v[72:73], v[56:57], v[76:77] op_sel:[0,0,0] op_sel_hi:[1,0,0]
    v_pk_mul_f32 v[60:61], v[60:61], v[58:59] op_sel:[0,0] op_sel_hi:[1,1]
    v_pk_mul_f32 v[64:65], v[64:65], v[62:63] op_sel:[0,0] op_sel_hi:[1,1]
    v_pk_mul_f32 v[68:69], v[68:69], v[66:67] op_sel:[0,0] op_sel_hi:[1,1]
    v_pk_mul_f32 v[72:73], v[72:73], v[70:71] op_sel:[0,0] op_sel_hi:[1,1]
    v_exp_f32 v60, v60
    v_exp_f32 v61, v61
    v_pk_mul_f32 v[58:59], v[58:59], v[118:119] op_sel:[0,0] op_sel_hi:[1,0]
    v_exp_f32 v64, v64
    v_exp_f32 v65, v65
    v_pk_mul_f32 v[62:63], v[62:63], v[118:119] op_sel:[0,0] op_sel_hi:[1,0]
    v_exp_f32 v68, v68
    v_exp_f32 v69, v69
    v_pk_mul_f32 v[66:67], v[66:67], v[118:119] op_sel:[0,0] op_sel_hi:[1,0]
    v_exp_f32 v72, v72
    v_exp_f32 v73, v73
    v_pk_mul_f32 v[70:71], v[70:71], v[118:119] op_sel:[0,0] op_sel_hi:[1,0]
    v_pk_add_f32 v[60:61], v[60:61], v[78:79] op_sel:[0,0] op_sel_hi:[1,0]
    v_pk_add_f32 v[64:65], v[64:65], v[78:79] op_sel:[0,0] op_sel_hi:[1,0]
    v_pk_add_f32 v[68:69], v[68:69], v[78:79] op_sel:[0,0] op_sel_hi:[1,0]
    v_pk_add_f32 v[72:73], v[72:73], v[78:79] op_sel:[0,0] op_sel_hi:[1,0]
    v_rcp_f32 v60, v60
    v_rcp_f32 v61, v61
    v_rcp_f32 v64, v64
    v_rcp_f32 v65, v65
    v_rcp_f32 v68, v68
    v_rcp_f32 v69, v69
    v_rcp_f32 v72, v72
    v_rcp_f32 v73, v73
    v_pk_fma_f32 v[140:141], v[58:59], v[60:61], v[140:141] op_sel:[0,0,0] op_sel_hi:[1,1,1]
    v_pk_fma_f32 v[142:143], v[62:63], v[64:65], v[142:143] op_sel:[0,0,0] op_sel_hi:[1,1,1]
    v_pk_fma_f32 v[144:145], v[66:67], v[68:69], v[144:145] op_sel:[0,0,0] op_sel_hi:[1,1,1]
    v_pk_fma_f32 v[146:147], v[70:71], v[72:73], v[146:147] op_sel:[0,0,0] op_sel_hi:[1,1,1]
    v_pk_fma_f32 v[58:59], s[82:83], v[90:91], v[104:105] op_sel:[0,0,0] op_sel_hi:[1,0,0]
    v_pk_fma_f32 v[62:63], s[84:85], v[90:91], v[104:105] op_sel:[0,0,0] op_sel_hi:[1,0,0]
    v_pk_fma_f32 v[66:67], s[86:87], v[90:91], v[104:105] op_sel:[0,0,0] op_sel_hi:[1,0,0]
    v_pk_fma_f32 v[70:71], s[88:89], v[90:91], v[104:105] op_sel:[0,0,0] op_sel_hi:[1,0,0]
    v_pk_mul_f32 v[60:61], v[58:59], v[58:59] op_sel:[0,0] op_sel_hi:[1,1]
    v_pk_mul_f32 v[64:65], v[62:63], v[62:63] op_sel:[0,0] op_sel_hi:[1,1]
    v_pk_mul_f32 v[68:69], v[66:67], v[66:67] op_sel:[0,0] op_sel_hi:[1,1]
    v_pk_mul_f32 v[72:73], v[70:71], v[70:71] op_sel:[0,0] op_sel_hi:[1,1]
    v_pk_fma_f32 v[60:61], v[60:61], v[56:57], v[76:77] op_sel:[0,0,0] op_sel_hi:[1,0,0]
    v_pk_fma_f32 v[64:65], v[64:65], v[56:57], v[76:77] op_sel:[0,0,0] op_sel_hi:[1,0,0]
    v_pk_fma_f32 v[68:69], v[68:69], v[56:57], v[76:77] op_sel:[0,0,0] op_sel_hi:[1,0,0]
    v_pk_fma_f32 v[72:73], v[72:73], v[56:57], v[76:77] op_sel:[0,0,0] op_sel_hi:[1,0,0]
    v_pk_mul_f32 v[60:61], v[60:61], v[58:59] op_sel:[0,0] op_sel_hi:[1,1]
    v_pk_mul_f32 v[64:65], v[64:65], v[62:63] op_sel:[0,0] op_sel_hi:[1,1]
    v_pk_mul_f32 v[68:69], v[68:69], v[66:67] op_sel:[0,0] op_sel_hi:[1,1]
    v_pk_mul_f32 v[72:73], v[72:73], v[70:71] op_sel:[0,0] op_sel_hi:[1,1]
    v_exp_f32 v60, v60
    v_exp_f32 v61, v61
    v_pk_mul_f32 v[58:59], v[58:59], v[118:119] op_sel:[0,0] op_sel_hi:[1,0]
    v_exp_f32 v64, v64
    v_exp_f32 v65, v65
    v_pk_mul_f32 v[62:63], v[62:63], v[118:119] op_sel:[0,0] op_sel_hi:[1,0]
    v_exp_f32 v68, v68
    v_exp_f32 v69, v69
    v_pk_mul_f32 v[66:67], v[66:67], v[118:119] op_sel:[0,0] op_sel_hi:[1,0]
    v_exp_f32 v72, v72
    v_exp_f32 v73, v73
    v_pk_mul_f32 v[70:71], v[70:71], v[118:119] op_sel:[0,0] op_sel_hi:[1,0]
    v_pk_add_f32 v[60:61], v[60:61], v[78:79] op_sel:[0,0] op_sel_hi:[1,0]
    v_pk_add_f32 v[64:65], v[64:65], v[78:79] op_sel:[0,0] op_sel_hi:[1,0]
    v_pk_add_f32 v[68:69], v[68:69], v[78:79] op_sel:[0,0] op_sel_hi:[1,0]
    v_pk_add_f32 v[72:73], v[72:73], v[78:79] op_sel:[0,0] op_sel_hi:[1,0]
    v_rcp_f32 v60, v60
    v_rcp_f32 v61, v61
    v_rcp_f32 v64, v64
    v_rcp_f32 v65, v65
    v_rcp_f32 v68, v68
    v_rcp_f32 v69, v69
    v_rcp_f32 v72, v72
    v_rcp_f32 v73, v73
    v_pk_fma_f32 v[148:149], v[58:59], v[60:61], v[148:149] op_sel:[0,0,0] op_sel_hi:[1,1,1]
    v_pk_fma_f32 v[150:151], v[62:63], v[64:65], v[150:151] op_sel:[0,0,0] op_sel_hi:[1,1,1]
    v_pk_fma_f32 v[152:153], v[66:67], v[68:69], v[152:153] op_sel:[0,0,0] op_sel_hi:[1,1,1]
    v_pk_fma_f32 v[154:155], v[70:71], v[72:73], v[154:155] op_sel:[0,0,0] op_sel_hi:[1,1,1]
    v_pk_fma_f32 v[58:59], s[58:59], v[92:93], v[106:107] op_sel:[0,0,0] op_sel_hi:[1,0,0]
    v_pk_fma_f32 v[62:63], s[60:61], v[92:93], v[106:107] op_sel:[0,0,0] op_sel_hi:[1,0,0]
    v_pk_fma_f32 v[66:67], s[62:63], v[92:93], v[106:107] op_sel:[0,0,0] op_sel_hi:[1,0,0]
    v_pk_fma_f32 v[70:71], s[64:65], v[92:93], v[106:107] op_sel:[0,0,0] op_sel_hi:[1,0,0]
    v_pk_mul_f32 v[60:61], v[58:59], v[58:59] op_sel:[0,0] op_sel_hi:[1,1]
    v_pk_mul_f32 v[64:65], v[62:63], v[62:63] op_sel:[0,0] op_sel_hi:[1,1]
    v_pk_mul_f32 v[68:69], v[66:67], v[66:67] op_sel:[0,0] op_sel_hi:[1,1]
    v_pk_mul_f32 v[72:73], v[70:71], v[70:71] op_sel:[0,0] op_sel_hi:[1,1]
    v_pk_fma_f32 v[60:61], v[60:61], v[56:57], v[76:77] op_sel:[0,0,0] op_sel_hi:[1,0,0]
    v_pk_fma_f32 v[64:65], v[64:65], v[56:57], v[76:77] op_sel:[0,0,0] op_sel_hi:[1,0,0]
    v_pk_fma_f32 v[68:69], v[68:69], v[56:57], v[76:77] op_sel:[0,0,0] op_sel_hi:[1,0,0]
    v_pk_fma_f32 v[72:73], v[72:73], v[56:57], v[76:77] op_sel:[0,0,0] op_sel_hi:[1,0,0]
    v_pk_mul_f32 v[60:61], v[60:61], v[58:59] op_sel:[0,0] op_sel_hi:[1,1]
    v_pk_mul_f32 v[64:65], v[64:65], v[62:63] op_sel:[0,0] op_sel_hi:[1,1]
    v_pk_mul_f32 v[68:69], v[68:69], v[66:67] op_sel:[0,0] op_sel_hi:[1,1]
    v_pk_mul_f32 v[72:73], v[72:73], v[70:71] op_sel:[0,0] op_sel_hi:[1,1]
    v_exp_f32 v60, v60
    v_exp_f32 v61, v61
    v_pk_mul_f32 v[58:59], v[58:59], v[120:121] op_sel:[0,0] op_sel_hi:[1,0]
    v_exp_f32 v64, v64
    v_exp_f32 v65, v65
    v_pk_mul_f32 v[62:63], v[62:63], v[120:121] op_sel:[0,0] op_sel_hi:[1,0]
    v_exp_f32 v68, v68
    v_exp_f32 v69, v69
    v_pk_mul_f32 v[66:67], v[66:67], v[120:121] op_sel:[0,0] op_sel_hi:[1,0]
    v_exp_f32 v72, v72
    v_exp_f32 v73, v73
    v_pk_mul_f32 v[70:71], v[70:71], v[120:121] op_sel:[0,0] op_sel_hi:[1,0]
    v_pk_add_f32 v[60:61], v[60:61], v[78:79] op_sel:[0,0] op_sel_hi:[1,0]
    v_pk_add_f32 v[64:65], v[64:65], v[78:79] op_sel:[0,0] op_sel_hi:[1,0]
    v_pk_add_f32 v[68:69], v[68:69], v[78:79] op_sel:[0,0] op_sel_hi:[1,0]
    v_pk_add_f32 v[72:73], v[72:73], v[78:79] op_sel:[0,0] op_sel_hi:[1,0]
    v_rcp_f32 v60, v60
    v_rcp_f32 v61, v61
    v_rcp_f32 v64, v64
    v_rcp_f32 v65, v65
    v_rcp_f32 v68, v68
    v_rcp_f32 v69, v69
    v_rcp_f32 v72, v72
    v_rcp_f32 v73, v73
    v_pk_fma_f32 v[124:125], v[58:59], v[60:61], v[124:125] op_sel:[0,0,0] op_sel_hi:[1,1,1]
    v_pk_fma_f32 v[126:127], v[62:63], v[64:65], v[126:127] op_sel:[0,0,0] op_sel_hi:[1,1,1]
    v_pk_fma_f32 v[128:129], v[66:67], v[68:69], v[128:129] op_sel:[0,0,0] op_sel_hi:[1,1,1]
    v_pk_fma_f32 v[130:131], v[70:71], v[72:73], v[130:131] op_sel:[0,0,0] op_sel_hi:[1,1,1]
    v_pk_fma_f32 v[58:59], s[66:67], v[92:93], v[106:107] op_sel:[0,0,0] op_sel_hi:[1,0,0]
    v_pk_fma_f32 v[62:63], s[68:69], v[92:93], v[106:107] op_sel:[0,0,0] op_sel_hi:[1,0,0]
    v_pk_fma_f32 v[66:67], s[70:71], v[92:93], v[106:107] op_sel:[0,0,0] op_sel_hi:[1,0,0]
    v_pk_fma_f32 v[70:71], s[72:73], v[92:93], v[106:107] op_sel:[0,0,0] op_sel_hi:[1,0,0]
    v_pk_mul_f32 v[60:61], v[58:59], v[58:59] op_sel:[0,0] op_sel_hi:[1,1]
    v_pk_mul_f32 v[64:65], v[62:63], v[62:63] op_sel:[0,0] op_sel_hi:[1,1]
    v_pk_mul_f32 v[68:69], v[66:67], v[66:67] op_sel:[0,0] op_sel_hi:[1,1]
    v_pk_mul_f32 v[72:73], v[70:71], v[70:71] op_sel:[0,0] op_sel_hi:[1,1]
    v_pk_fma_f32 v[60:61], v[60:61], v[56:57], v[76:77] op_sel:[0,0,0] op_sel_hi:[1,0,0]
    v_pk_fma_f32 v[64:65], v[64:65], v[56:57], v[76:77] op_sel:[0,0,0] op_sel_hi:[1,0,0]
    v_pk_fma_f32 v[68:69], v[68:69], v[56:57], v[76:77] op_sel:[0,0,0] op_sel_hi:[1,0,0]
    v_pk_fma_f32 v[72:73], v[72:73], v[56:57], v[76:77] op_sel:[0,0,0] op_sel_hi:[1,0,0]
    v_pk_mul_f32 v[60:61], v[60:61], v[58:59] op_sel:[0,0] op_sel_hi:[1,1]
    v_pk_mul_f32 v[64:65], v[64:65], v[62:63] op_sel:[0,0] op_sel_hi:[1,1]
    v_pk_mul_f32 v[68:69], v[68:69], v[66:67] op_sel:[0,0] op_sel_hi:[1,1]
    v_pk_mul_f32 v[72:73], v[72:73], v[70:71] op_sel:[0,0] op_sel_hi:[1,1]
    v_exp_f32 v60, v60
    v_exp_f32 v61, v61
    v_pk_mul_f32 v[58:59], v[58:59], v[120:121] op_sel:[0,0] op_sel_hi:[1,0]
    v_exp_f32 v64, v64
    v_exp_f32 v65, v65
    v_pk_mul_f32 v[62:63], v[62:63], v[120:121] op_sel:[0,0] op_sel_hi:[1,0]
    v_exp_f32 v68, v68
    v_exp_f32 v69, v69
    v_pk_mul_f32 v[66:67], v[66:67], v[120:121] op_sel:[0,0] op_sel_hi:[1,0]
    v_exp_f32 v72, v72
    v_exp_f32 v73, v73
    v_pk_mul_f32 v[70:71], v[70:71], v[120:121] op_sel:[0,0] op_sel_hi:[1,0]
    v_pk_add_f32 v[60:61], v[60:61], v[78:79] op_sel:[0,0] op_sel_hi:[1,0]
    v_pk_add_f32 v[64:65], v[64:65], v[78:79] op_sel:[0,0] op_sel_hi:[1,0]
    v_pk_add_f32 v[68:69], v[68:69], v[78:79] op_sel:[0,0] op_sel_hi:[1,0]
    v_pk_add_f32 v[72:73], v[72:73], v[78:79] op_sel:[0,0] op_sel_hi:[1,0]
    v_rcp_f32 v60, v60
    v_rcp_f32 v61, v61
    v_rcp_f32 v64, v64
    v_rcp_f32 v65, v65
    v_rcp_f32 v68, v68
    v_rcp_f32 v69, v69
    v_rcp_f32 v72, v72
    v_rcp_f32 v73, v73
    v_pk_fma_f32 v[132:133], v[58:59], v[60:61], v[132:133] op_sel:[0,0,0] op_sel_hi:[1,1,1]
    v_pk_fma_f32 v[134:135], v[62:63], v[64:65], v[134:135] op_sel:[0,0,0] op_sel_hi:[1,1,1]
    v_pk_fma_f32 v[136:137], v[66:67], v[68:69], v[136:137] op_sel:[0,0,0] op_sel_hi:[1,1,1]
    v_pk_fma_f32 v[138:139], v[70:71], v[72:73], v[138:139] op_sel:[0,0,0] op_sel_hi:[1,1,1]
    v_pk_fma_f32 v[58:59], s[74:75], v[92:93], v[106:107] op_sel:[0,0,0] op_sel_hi:[1,0,0]
    v_pk_fma_f32 v[62:63], s[76:77], v[92:93], v[106:107] op_sel:[0,0,0] op_sel_hi:[1,0,0]
    v_pk_fma_f32 v[66:67], s[78:79], v[92:93], v[106:107] op_sel:[0,0,0] op_sel_hi:[1,0,0]
    v_pk_fma_f32 v[70:71], s[80:81], v[92:93], v[106:107] op_sel:[0,0,0] op_sel_hi:[1,0,0]
    v_pk_mul_f32 v[60:61], v[58:59], v[58:59] op_sel:[0,0] op_sel_hi:[1,1]
    v_pk_mul_f32 v[64:65], v[62:63], v[62:63] op_sel:[0,0] op_sel_hi:[1,1]
    v_pk_mul_f32 v[68:69], v[66:67], v[66:67] op_sel:[0,0] op_sel_hi:[1,1]
    v_pk_mul_f32 v[72:73], v[70:71], v[70:71] op_sel:[0,0] op_sel_hi:[1,1]
    v_pk_fma_f32 v[60:61], v[60:61], v[56:57], v[76:77] op_sel:[0,0,0] op_sel_hi:[1,0,0]
    v_pk_fma_f32 v[64:65], v[64:65], v[56:57], v[76:77] op_sel:[0,0,0] op_sel_hi:[1,0,0]
    v_pk_fma_f32 v[68:69], v[68:69], v[56:57], v[76:77] op_sel:[0,0,0] op_sel_hi:[1,0,0]
    v_pk_fma_f32 v[72:73], v[72:73], v[56:57], v[76:77] op_sel:[0,0,0] op_sel_hi:[1,0,0]
    v_pk_mul_f32 v[60:61], v[60:61], v[58:59] op_sel:[0,0] op_sel_hi:[1,1]
    v_pk_mul_f32 v[64:65], v[64:65], v[62:63] op_sel:[0,0] op_sel_hi:[1,1]
    v_pk_mul_f32 v[68:69], v[68:69], v[66:67] op_sel:[0,0] op_sel_hi:[1,1]
    v_pk_mul_f32 v[72:73], v[72:73], v[70:71] op_sel:[0,0] op_sel_hi:[1,1]
    v_exp_f32 v60, v60
    v_exp_f32 v61, v61
    v_pk_mul_f32 v[58:59], v[58:59], v[120:121] op_sel:[0,0] op_sel_hi:[1,0]
    v_exp_f32 v64, v64
    v_exp_f32 v65, v65
    v_pk_mul_f32 v[62:63], v[62:63], v[120:121] op_sel:[0,0] op_sel_hi:[1,0]
    v_exp_f32 v68, v68
    v_exp_f32 v69, v69
    v_pk_mul_f32 v[66:67], v[66:67], v[120:121] op_sel:[0,0] op_sel_hi:[1,0]
    v_exp_f32 v72, v72
    v_exp_f32 v73, v73
    v_pk_mul_f32 v[70:71], v[70:71], v[120:121] op_sel:[0,0] op_sel_hi:[1,0]
    v_pk_add_f32 v[60:61], v[60:61], v[78:79] op_sel:[0,0] op_sel_hi:[1,0]
    v_pk_add_f32 v[64:65], v[64:65], v[78:79] op_sel:[0,0] op_sel_hi:[1,0]
    v_pk_add_f32 v[68:69], v[68:69], v[78:79] op_sel:[0,0] op_sel_hi:[1,0]
    v_pk_add_f32 v[72:73], v[72:73], v[78:79] op_sel:[0,0] op_sel_hi:[1,0]
    v_rcp_f32 v60, v60
    v_rcp_f32 v61, v61
    v_rcp_f32 v64, v64
    v_rcp_f32 v65, v65
    v_rcp_f32 v68, v68
    v_rcp_f32 v69, v69
    v_rcp_f32 v72, v72
    v_rcp_f32 v73, v73
    v_pk_fma_f32 v[140:141], v[58:59], v[60:61], v[140:141] op_sel:[0,0,0] op_sel_hi:[1,1,1]
    v_pk_fma_f32 v[142:143], v[62:63], v[64:65], v[142:143] op_sel:[0,0,0] op_sel_hi:[1,1,1]
    v_pk_fma_f32 v[144:145], v[66:67], v[68:69], v[144:145] op_sel:[0,0,0] op_sel_hi:[1,1,1]
    v_pk_fma_f32 v[146:147], v[70:71], v[72:73], v[146:147] op_sel:[0,0,0] op_sel_hi:[1,1,1]
    v_pk_fma_f32 v[58:59], s[82:83], v[92:93], v[106:107] op_sel:[0,0,0] op_sel_hi:[1,0,0]
    v_pk_fma_f32 v[62:63], s[84:85], v[92:93], v[106:107] op_sel:[0,0,0] op_sel_hi:[1,0,0]
    v_pk_fma_f32 v[66:67], s[86:87], v[92:93], v[106:107] op_sel:[0,0,0] op_sel_hi:[1,0,0]
    v_pk_fma_f32 v[70:71], s[88:89], v[92:93], v[106:107] op_sel:[0,0,0] op_sel_hi:[1,0,0]
    v_pk_mul_f32 v[60:61], v[58:59], v[58:59] op_sel:[0,0] op_sel_hi:[1,1]
    v_pk_mul_f32 v[64:65], v[62:63], v[62:63] op_sel:[0,0] op_sel_hi:[1,1]
    v_pk_mul_f32 v[68:69], v[66:67], v[66:67] op_sel:[0,0] op_sel_hi:[1,1]
    v_pk_mul_f32 v[72:73], v[70:71], v[70:71] op_sel:[0,0] op_sel_hi:[1,1]
    v_pk_fma_f32 v[60:61], v[60:61], v[56:57], v[76:77] op_sel:[0,0,0] op_sel_hi:[1,0,0]
    v_pk_fma_f32 v[64:65], v[64:65], v[56:57], v[76:77] op_sel:[0,0,0] op_sel_hi:[1,0,0]
    v_pk_fma_f32 v[68:69], v[68:69], v[56:57], v[76:77] op_sel:[0,0,0] op_sel_hi:[1,0,0]
    v_pk_fma_f32 v[72:73], v[72:73], v[56:57], v[76:77] op_sel:[0,0,0] op_sel_hi:[1,0,0]
    v_pk_mul_f32 v[60:61], v[60:61], v[58:59] op_sel:[0,0] op_sel_hi:[1,1]
    v_pk_mul_f32 v[64:65], v[64:65], v[62:63] op_sel:[0,0] op_sel_hi:[1,1]
    v_pk_mul_f32 v[68:69], v[68:69], v[66:67] op_sel:[0,0] op_sel_hi:[1,1]
    v_pk_mul_f32 v[72:73], v[72:73], v[70:71] op_sel:[0,0] op_sel_hi:[1,1]
    v_exp_f32 v60, v60
    v_exp_f32 v61, v61
    v_pk_mul_f32 v[58:59], v[58:59], v[120:121] op_sel:[0,0] op_sel_hi:[1,0]
    v_exp_f32 v64, v64
    v_exp_f32 v65, v65
    v_pk_mul_f32 v[62:63], v[62:63], v[120:121] op_sel:[0,0] op_sel_hi:[1,0]
    v_exp_f32 v68, v68
    v_exp_f32 v69, v69
    v_pk_mul_f32 v[66:67], v[66:67], v[120:121] op_sel:[0,0] op_sel_hi:[1,0]
    v_exp_f32 v72, v72
    v_exp_f32 v73, v73
    v_pk_mul_f32 v[70:71], v[70:71], v[120:121] op_sel:[0,0] op_sel_hi:[1,0]
    v_pk_add_f32 v[60:61], v[60:61], v[78:79] op_sel:[0,0] op_sel_hi:[1,0]
    v_pk_add_f32 v[64:65], v[64:65], v[78:79] op_sel:[0,0] op_sel_hi:[1,0]
    v_pk_add_f32 v[68:69], v[68:69], v[78:79] op_sel:[0,0] op_sel_hi:[1,0]
    v_pk_add_f32 v[72:73], v[72:73], v[78:79] op_sel:[0,0] op_sel_hi:[1,0]
    v_rcp_f32 v60, v60
    v_rcp_f32 v61, v61
    v_rcp_f32 v64, v64
    v_rcp_f32 v65, v65
    v_rcp_f32 v68, v68
    v_rcp_f32 v69, v69
    v_rcp_f32 v72, v72
    v_rcp_f32 v73, v73
    v_pk_fma_f32 v[148:149], v[58:59], v[60:61], v[148:149] op_sel:[0,0,0] op_sel_hi:[1,1,1]
    v_pk_fma_f32 v[150:151], v[62:63], v[64:65], v[150:151] op_sel:[0,0,0] op_sel_hi:[1,1,1]
    v_pk_fma_f32 v[152:153], v[66:67], v[68:69], v[152:153] op_sel:[0,0,0] op_sel_hi:[1,1,1]
    v_pk_fma_f32 v[154:155], v[70:71], v[72:73], v[154:155] op_sel:[0,0,0] op_sel_hi:[1,1,1]
    s_lshl_b32 s57, s34, 12
    s_add_u32 s57, s57, 147456
    s_add_u32 m0, s57, 3072
    v_xor_b32 v156, 96, v160
    s_add_u32 s56, s35, 6144
    buffer_load_dwordx4 v156, s[24:27], s56 offen nt lds
    v_pk_fma_f32 v[58:59], s[58:59], v[94:95], v[108:109] op_sel:[0,0,0] op_sel_hi:[1,0,0]
    v_pk_fma_f32 v[62:63], s[60:61], v[94:95], v[108:109] op_sel:[0,0,0] op_sel_hi:[1,0,0]
    v_pk_fma_f32 v[66:67], s[62:63], v[94:95], v[108:109] op_sel:[0,0,0] op_sel_hi:[1,0,0]
    v_pk_fma_f32 v[70:71], s[64:65], v[94:95], v[108:109] op_sel:[0,0,0] op_sel_hi:[1,0,0]
    v_pk_mul_f32 v[60:61], v[58:59], v[58:59] op_sel:[0,0] op_sel_hi:[1,1]
    v_pk_mul_f32 v[64:65], v[62:63], v[62:63] op_sel:[0,0] op_sel_hi:[1,1]
    v_pk_mul_f32 v[68:69], v[66:67], v[66:67] op_sel:[0,0] op_sel_hi:[1,1]
    v_pk_mul_f32 v[72:73], v[70:71], v[70:71] op_sel:[0,0] op_sel_hi:[1,1]
    v_pk_fma_f32 v[60:61], v[60:61], v[56:57], v[76:77] op_sel:[0,0,0] op_sel_hi:[1,0,0]
    v_pk_fma_f32 v[64:65], v[64:65], v[56:57], v[76:77] op_sel:[0,0,0] op_sel_hi:[1,0,0]
    v_pk_fma_f32 v[68:69], v[68:69], v[56:57], v[76:77] op_sel:[0,0,0] op_sel_hi:[1,0,0]
    v_pk_fma_f32 v[72:73], v[72:73], v[56:57], v[76:77] op_sel:[0,0,0] op_sel_hi:[1,0,0]
    v_pk_mul_f32 v[60:61], v[60:61], v[58:59] op_sel:[0,0] op_sel_hi:[1,1]
    v_pk_mul_f32 v[64:65], v[64:65], v[62:63] op_sel:[0,0] op_sel_hi:[1,1]
    v_pk_mul_f32 v[68:69], v[68:69], v[66:67] op_sel:[0,0] op_sel_hi:[1,1]
    v_pk_mul_f32 v[72:73], v[72:73], v[70:71] op_sel:[0,0] op_sel_hi:[1,1]
    v_exp_f32 v60, v60
    v_exp_f32 v61, v61
    v_pk_mul_f32 v[58:59], v[58:59], v[122:123] op_sel:[0,0] op_sel_hi:[1,0]
    v_exp_f32 v64, v64
    v_exp_f32 v65, v65
    v_pk_mul_f32 v[62:63], v[62:63], v[122:123] op_sel:[0,0] op_sel_hi:[1,0]
    v_exp_f32 v68, v68
    v_exp_f32 v69, v69
    v_pk_mul_f32 v[66:67], v[66:67], v[122:123] op_sel:[0,0] op_sel_hi:[1,0]
    v_exp_f32 v72, v72
    v_exp_f32 v73, v73
    v_pk_mul_f32 v[70:71], v[70:71], v[122:123] op_sel:[0,0] op_sel_hi:[1,0]
    v_pk_add_f32 v[60:61], v[60:61], v[78:79] op_sel:[0,0] op_sel_hi:[1,0]
    v_pk_add_f32 v[64:65], v[64:65], v[78:79] op_sel:[0,0] op_sel_hi:[1,0]
    v_pk_add_f32 v[68:69], v[68:69], v[78:79] op_sel:[0,0] op_sel_hi:[1,0]
    v_pk_add_f32 v[72:73], v[72:73], v[78:79] op_sel:[0,0] op_sel_hi:[1,0]
    v_rcp_f32 v60, v60
    v_rcp_f32 v61, v61
    v_rcp_f32 v64, v64
    v_rcp_f32 v65, v65
    v_rcp_f32 v68, v68
    v_rcp_f32 v69, v69
    v_rcp_f32 v72, v72
    v_rcp_f32 v73, v73
    v_pk_fma_f32 v[124:125], v[58:59], v[60:61], v[124:125] op_sel:[0,0,0] op_sel_hi:[1,1,1]
    v_pk_fma_f32 v[126:127], v[62:63], v[64:65], v[126:127] op_sel:[0,0,0] op_sel_hi:[1,1,1]
    v_pk_fma_f32 v[128:129], v[66:67], v[68:69], v[128:129] op_sel:[0,0,0] op_sel_hi:[1,1,1]
    v_pk_fma_f32 v[130:131], v[70:71], v[72:73], v[130:131] op_sel:[0,0,0] op_sel_hi:[1,1,1]
    v_pk_fma_f32 v[58:59], s[66:67], v[94:95], v[108:109] op_sel:[0,0,0] op_sel_hi:[1,0,0]
    v_pk_fma_f32 v[62:63], s[68:69], v[94:95], v[108:109] op_sel:[0,0,0] op_sel_hi:[1,0,0]
    v_pk_fma_f32 v[66:67], s[70:71], v[94:95], v[108:109] op_sel:[0,0,0] op_sel_hi:[1,0,0]
    v_pk_fma_f32 v[70:71], s[72:73], v[94:95], v[108:109] op_sel:[0,0,0] op_sel_hi:[1,0,0]
    v_pk_mul_f32 v[60:61], v[58:59], v[58:59] op_sel:[0,0] op_sel_hi:[1,1]
    v_pk_mul_f32 v[64:65], v[62:63], v[62:63] op_sel:[0,0] op_sel_hi:[1,1]
    v_pk_mul_f32 v[68:69], v[66:67], v[66:67] op_sel:[0,0] op_sel_hi:[1,1]
    v_pk_mul_f32 v[72:73], v[70:71], v[70:71] op_sel:[0,0] op_sel_hi:[1,1]
    v_pk_fma_f32 v[60:61], v[60:61], v[56:57], v[76:77] op_sel:[0,0,0] op_sel_hi:[1,0,0]
    v_pk_fma_f32 v[64:65], v[64:65], v[56:57], v[76:77] op_sel:[0,0,0] op_sel_hi:[1,0,0]
    v_pk_fma_f32 v[68:69], v[68:69], v[56:57], v[76:77] op_sel:[0,0,0] op_sel_hi:[1,0,0]
    v_pk_fma_f32 v[72:73], v[72:73], v[56:57], v[76:77] op_sel:[0,0,0] op_sel_hi:[1,0,0]
    v_pk_mul_f32 v[60:61], v[60:61], v[58:59] op_sel:[0,0] op_sel_hi:[1,1]
    v_pk_mul_f32 v[64:65], v[64:65], v[62:63] op_sel:[0,0] op_sel_hi:[1,1]
    v_pk_mul_f32 v[68:69], v[68:69], v[66:67] op_sel:[0,0] op_sel_hi:[1,1]
    v_pk_mul_f32 v[72:73], v[72:73], v[70:71] op_sel:[0,0] op_sel_hi:[1,1]
    v_exp_f32 v60, v60
    v_exp_f32 v61, v61
    v_pk_mul_f32 v[58:59], v[58:59], v[122:123] op_sel:[0,0] op_sel_hi:[1,0]
    v_exp_f32 v64, v64
    v_exp_f32 v65, v65
    v_pk_mul_f32 v[62:63], v[62:63], v[122:123] op_sel:[0,0] op_sel_hi:[1,0]
    v_exp_f32 v68, v68
    v_exp_f32 v69, v69
    v_pk_mul_f32 v[66:67], v[66:67], v[122:123] op_sel:[0,0] op_sel_hi:[1,0]
    v_exp_f32 v72, v72
    v_exp_f32 v73, v73
    v_pk_mul_f32 v[70:71], v[70:71], v[122:123] op_sel:[0,0] op_sel_hi:[1,0]
    v_pk_add_f32 v[60:61], v[60:61], v[78:79] op_sel:[0,0] op_sel_hi:[1,0]
    v_pk_add_f32 v[64:65], v[64:65], v[78:79] op_sel:[0,0] op_sel_hi:[1,0]
    v_pk_add_f32 v[68:69], v[68:69], v[78:79] op_sel:[0,0] op_sel_hi:[1,0]
    v_pk_add_f32 v[72:73], v[72:73], v[78:79] op_sel:[0,0] op_sel_hi:[1,0]
    v_rcp_f32 v60, v60
    v_rcp_f32 v61, v61
    v_rcp_f32 v64, v64
    v_rcp_f32 v65, v65
    v_rcp_f32 v68, v68
    v_rcp_f32 v69, v69
    v_rcp_f32 v72, v72
    v_rcp_f32 v73, v73
    v_pk_fma_f32 v[132:133], v[58:59], v[60:61], v[132:133] op_sel:[0,0,0] op_sel_hi:[1,1,1]
    v_pk_fma_f32 v[134:135], v[62:63], v[64:65], v[134:135] op_sel:[0,0,0] op_sel_hi:[1,1,1]
    v_pk_fma_f32 v[136:137], v[66:67], v[68:69], v[136:137] op_sel:[0,0,0] op_sel_hi:[1,1,1]
    v_pk_fma_f32 v[138:139], v[70:71], v[72:73], v[138:139] op_sel:[0,0,0] op_sel_hi:[1,1,1]
    v_pk_fma_f32 v[58:59], s[74:75], v[94:95], v[108:109] op_sel:[0,0,0] op_sel_hi:[1,0,0]
    v_pk_fma_f32 v[62:63], s[76:77], v[94:95], v[108:109] op_sel:[0,0,0] op_sel_hi:[1,0,0]
    v_pk_fma_f32 v[66:67], s[78:79], v[94:95], v[108:109] op_sel:[0,0,0] op_sel_hi:[1,0,0]
    v_pk_fma_f32 v[70:71], s[80:81], v[94:95], v[108:109] op_sel:[0,0,0] op_sel_hi:[1,0,0]
    v_pk_mul_f32 v[60:61], v[58:59], v[58:59] op_sel:[0,0] op_sel_hi:[1,1]
    v_pk_mul_f32 v[64:65], v[62:63], v[62:63] op_sel:[0,0] op_sel_hi:[1,1]
    v_pk_mul_f32 v[68:69], v[66:67], v[66:67] op_sel:[0,0] op_sel_hi:[1,1]
    v_pk_mul_f32 v[72:73], v[70:71], v[70:71] op_sel:[0,0] op_sel_hi:[1,1]
    v_pk_fma_f32 v[60:61], v[60:61], v[56:57], v[76:77] op_sel:[0,0,0] op_sel_hi:[1,0,0]
    v_pk_fma_f32 v[64:65], v[64:65], v[56:57], v[76:77] op_sel:[0,0,0] op_sel_hi:[1,0,0]
    v_pk_fma_f32 v[68:69], v[68:69], v[56:57], v[76:77] op_sel:[0,0,0] op_sel_hi:[1,0,0]
    v_pk_fma_f32 v[72:73], v[72:73], v[56:57], v[76:77] op_sel:[0,0,0] op_sel_hi:[1,0,0]
    v_pk_mul_f32 v[60:61], v[60:61], v[58:59] op_sel:[0,0] op_sel_hi:[1,1]
    v_pk_mul_f32 v[64:65], v[64:65], v[62:63] op_sel:[0,0] op_sel_hi:[1,1]
    v_pk_mul_f32 v[68:69], v[68:69], v[66:67] op_sel:[0,0] op_sel_hi:[1,1]
    v_pk_mul_f32 v[72:73], v[72:73], v[70:71] op_sel:[0,0] op_sel_hi:[1,1]
    v_exp_f32 v60, v60
    v_exp_f32 v61, v61
    v_pk_mul_f32 v[58:59], v[58:59], v[122:123] op_sel:[0,0] op_sel_hi:[1,0]
    v_exp_f32 v64, v64
    v_exp_f32 v65, v65
    v_pk_mul_f32 v[62:63], v[62:63], v[122:123] op_sel:[0,0] op_sel_hi:[1,0]
    v_exp_f32 v68, v68
    v_exp_f32 v69, v69
    v_pk_mul_f32 v[66:67], v[66:67], v[122:123] op_sel:[0,0] op_sel_hi:[1,0]
    v_exp_f32 v72, v72
    v_exp_f32 v73, v73
    v_pk_mul_f32 v[70:71], v[70:71], v[122:123] op_sel:[0,0] op_sel_hi:[1,0]
    v_pk_add_f32 v[60:61], v[60:61], v[78:79] op_sel:[0,0] op_sel_hi:[1,0]
    v_pk_add_f32 v[64:65], v[64:65], v[78:79] op_sel:[0,0] op_sel_hi:[1,0]
    v_pk_add_f32 v[68:69], v[68:69], v[78:79] op_sel:[0,0] op_sel_hi:[1,0]
    v_pk_add_f32 v[72:73], v[72:73], v[78:79] op_sel:[0,0] op_sel_hi:[1,0]
    v_rcp_f32 v60, v60
    v_rcp_f32 v61, v61
    v_rcp_f32 v64, v64
    v_rcp_f32 v65, v65
    v_rcp_f32 v68, v68
    v_rcp_f32 v69, v69
    v_rcp_f32 v72, v72
    v_rcp_f32 v73, v73
    v_pk_fma_f32 v[140:141], v[58:59], v[60:61], v[140:141] op_sel:[0,0,0] op_sel_hi:[1,1,1]
    v_pk_fma_f32 v[142:143], v[62:63], v[64:65], v[142:143] op_sel:[0,0,0] op_sel_hi:[1,1,1]
    v_pk_fma_f32 v[144:145], v[66:67], v[68:69], v[144:145] op_sel:[0,0,0] op_sel_hi:[1,1,1]
    v_pk_fma_f32 v[146:147], v[70:71], v[72:73], v[146:147] op_sel:[0,0,0] op_sel_hi:[1,1,1]
    v_pk_fma_f32 v[58:59], s[82:83], v[94:95], v[108:109] op_sel:[0,0,0] op_sel_hi:[1,0,0]
    v_pk_fma_f32 v[62:63], s[84:85], v[94:95], v[108:109] op_sel:[0,0,0] op_sel_hi:[1,0,0]
    v_pk_fma_f32 v[66:67], s[86:87], v[94:95], v[108:109] op_sel:[0,0,0] op_sel_hi:[1,0,0]
    v_pk_fma_f32 v[70:71], s[88:89], v[94:95], v[108:109] op_sel:[0,0,0] op_sel_hi:[1,0,0]
    v_pk_mul_f32 v[60:61], v[58:59], v[58:59] op_sel:[0,0] op_sel_hi:[1,1]
    v_pk_mul_f32 v[64:65], v[62:63], v[62:63] op_sel:[0,0] op_sel_hi:[1,1]
    v_pk_mul_f32 v[68:69], v[66:67], v[66:67] op_sel:[0,0] op_sel_hi:[1,1]
    v_pk_mul_f32 v[72:73], v[70:71], v[70:71] op_sel:[0,0] op_sel_hi:[1,1]
    v_pk_fma_f32 v[60:61], v[60:61], v[56:57], v[76:77] op_sel:[0,0,0] op_sel_hi:[1,0,0]
    v_pk_fma_f32 v[64:65], v[64:65], v[56:57], v[76:77] op_sel:[0,0,0] op_sel_hi:[1,0,0]
    v_pk_fma_f32 v[68:69], v[68:69], v[56:57], v[76:77] op_sel:[0,0,0] op_sel_hi:[1,0,0]
    v_pk_fma_f32 v[72:73], v[72:73], v[56:57], v[76:77] op_sel:[0,0,0] op_sel_hi:[1,0,0]
    v_pk_mul_f32 v[60:61], v[60:61], v[58:59] op_sel:[0,0] op_sel_hi:[1,1]
    v_pk_mul_f32 v[64:65], v[64:65], v[62:63] op_sel:[0,0] op_sel_hi:[1,1]
    v_pk_mul_f32 v[68:69], v[68:69], v[66:67] op_sel:[0,0] op_sel_hi:[1,1]
    v_pk_mul_f32 v[72:73], v[72:73], v[70:71] op_sel:[0,0] op_sel_hi:[1,1]
    v_exp_f32 v60, v60
    v_exp_f32 v61, v61
    v_pk_mul_f32 v[58:59], v[58:59], v[122:123] op_sel:[0,0] op_sel_hi:[1,0]
    v_exp_f32 v64, v64
    v_exp_f32 v65, v65
    v_pk_mul_f32 v[62:63], v[62:63], v[122:123] op_sel:[0,0] op_sel_hi:[1,0]
    v_exp_f32 v68, v68
    v_exp_f32 v69, v69
    v_pk_mul_f32 v[66:67], v[66:67], v[122:123] op_sel:[0,0] op_sel_hi:[1,0]
    v_exp_f32 v72, v72
    v_exp_f32 v73, v73
    v_pk_mul_f32 v[70:71], v[70:71], v[122:123] op_sel:[0,0] op_sel_hi:[1,0]
    v_pk_add_f32 v[60:61], v[60:61], v[78:79] op_sel:[0,0] op_sel_hi:[1,0]
    v_pk_add_f32 v[64:65], v[64:65], v[78:79] op_sel:[0,0] op_sel_hi:[1,0]
    v_pk_add_f32 v[68:69], v[68:69], v[78:79] op_sel:[0,0] op_sel_hi:[1,0]
    v_pk_add_f32 v[72:73], v[72:73], v[78:79] op_sel:[0,0] op_sel_hi:[1,0]
    v_rcp_f32 v60, v60
    v_rcp_f32 v61, v61
    v_rcp_f32 v64, v64
    v_rcp_f32 v65, v65
    v_rcp_f32 v68, v68
    v_rcp_f32 v69, v69
    v_rcp_f32 v72, v72
    v_rcp_f32 v73, v73
    v_pk_fma_f32 v[148:149], v[58:59], v[60:61], v[148:149] op_sel:[0,0,0] op_sel_hi:[1,1,1]
    v_pk_fma_f32 v[150:151], v[62:63], v[64:65], v[150:151] op_sel:[0,0,0] op_sel_hi:[1,1,1]
    v_pk_fma_f32 v[152:153], v[66:67], v[68:69], v[152:153] op_sel:[0,0,0] op_sel_hi:[1,1,1]
    v_pk_fma_f32 v[154:155], v[70:71], v[72:73], v[154:155] op_sel:[0,0,0] op_sel_hi:[1,1,1]
    v_permlane32_swap_b32 v124, v140
    v_permlane32_swap_b32 v125, v141
    v_permlane32_swap_b32 v126, v142
    v_permlane32_swap_b32 v127, v143
    v_permlane32_swap_b32 v128, v144
    v_permlane32_swap_b32 v129, v145
    v_permlane32_swap_b32 v130, v146
    v_permlane32_swap_b32 v131, v147
    v_permlane32_swap_b32 v132, v148
    v_permlane32_swap_b32 v133, v149
    v_permlane32_swap_b32 v134, v150
    v_permlane32_swap_b32 v135, v151
    v_permlane32_swap_b32 v136, v152
    v_permlane32_swap_b32 v137, v153
    v_permlane32_swap_b32 v138, v154
    v_permlane32_swap_b32 v139, v155
    v_add_f32 v124, v124, v140
    v_add_f32 v125, v125, v141
    v_add_f32 v126, v126, v142
    v_add_f32 v127, v127, v143
    v_add_f32 v128, v128, v144
    v_add_f32 v129, v129, v145
    v_add_f32 v130, v130, v146
    v_add_f32 v131, v131, v147
    v_add_f32 v132, v132, v148
    v_add_f32 v133, v133, v149
    v_add_f32 v134, v134, v150
    v_add_f32 v135, v135, v151
    v_add_f32 v136, v136, v152
    v_add_f32 v137, v137, v153
    v_add_f32 v138, v138, v154
    v_add_f32 v139, v139, v155
    v_permlane16_swap_b32 v124, v132
    v_permlane16_swap_b32 v125, v133
    v_permlane16_swap_b32 v126, v134
    v_permlane16_swap_b32 v127, v135
    v_permlane16_swap_b32 v128, v136
    v_permlane16_swap_b32 v129, v137
    v_permlane16_swap_b32 v130, v138
    v_permlane16_swap_b32 v131, v139
    v_add_f32 v124, v124, v132
    v_add_f32 v125, v125, v133
    v_add_f32 v126, v126, v134
    v_add_f32 v127, v127, v135
    v_add_f32 v128, v128, v136
    v_add_f32 v129, v129, v137
    v_add_f32 v130, v130, v138
    v_add_f32 v131, v131, v139
    v_add_f32_dpp v124, v124, v124 quad_perm:[1,0,3,2] row_mask:0xf bank_mask:0xf
    v_add_f32_dpp v125, v125, v125 quad_perm:[1,0,3,2] row_mask:0xf bank_mask:0xf
    v_add_f32_dpp v126, v126, v126 quad_perm:[1,0,3,2] row_mask:0xf bank_mask:0xf
    v_add_f32_dpp v127, v127, v127 quad_perm:[1,0,3,2] row_mask:0xf bank_mask:0xf
    v_add_f32_dpp v128, v128, v128 quad_perm:[1,0,3,2] row_mask:0xf bank_mask:0xf
    v_add_f32_dpp v129, v129, v129 quad_perm:[1,0,3,2] row_mask:0xf bank_mask:0xf
    v_add_f32_dpp v130, v130, v130 quad_perm:[1,0,3,2] row_mask:0xf bank_mask:0xf
    v_add_f32_dpp v131, v131, v131 quad_perm:[1,0,3,2] row_mask:0xf bank_mask:0xf
    v_add_f32_dpp v124, v124, v124 quad_perm:[2,3,0,1] row_mask:0xf bank_mask:0xf
    v_add_f32_dpp v125, v125, v125 quad_perm:[2,3,0,1] row_mask:0xf bank_mask:0xf
    v_add_f32_dpp v126, v126, v126 quad_perm:[2,3,0,1] row_mask:0xf bank_mask:0xf
    v_add_f32_dpp v127, v127, v127 quad_perm:[2,3,0,1] row_mask:0xf bank_mask:0xf
    v_add_f32_dpp v128, v128, v128 quad_perm:[2,3,0,1] row_mask:0xf bank_mask:0xf
    v_add_f32_dpp v129, v129, v129 quad_perm:[2,3,0,1] row_mask:0xf bank_mask:0xf
    v_add_f32_dpp v130, v130, v130 quad_perm:[2,3,0,1] row_mask:0xf bank_mask:0xf
    v_add_f32_dpp v131, v131, v131 quad_perm:[2,3,0,1] row_mask:0xf bank_mask:0xf
    v_add_f32_dpp v124, v124, v124 row_ror:4 row_mask:0xf bank_mask:0xf
    v_add_f32_dpp v125, v125, v125 row_ror:4 row_mask:0xf bank_mask:0xf
    v_add_f32_dpp v126, v126, v126 row_ror:4 row_mask:0xf bank_mask:0xf
    v_add_f32_dpp v127, v127, v127 row_ror:4 row_mask:0xf bank_mask:0xf
    v_add_f32_dpp v128, v128, v128 row_ror:4 row_mask:0xf bank_mask:0xf
    v_add_f32_dpp v129, v129, v129 row_ror:4 row_mask:0xf bank_mask:0xf
    v_add_f32_dpp v130, v130, v130 row_ror:4 row_mask:0xf bank_mask:0xf
    v_add_f32_dpp v131, v131, v131 row_ror:4 row_mask:0xf bank_mask:0xf
    v_add_f32_dpp v124, v124, v124 row_ror:8 row_mask:0xf bank_mask:0xf
    v_add_f32_dpp v125, v125, v125 row_ror:8 row_mask:0xf bank_mask:0xf
    v_add_f32_dpp v126, v126, v126 row_ror:8 row_mask:0xf bank_mask:0xf
    v_add_f32_dpp v127, v127, v127 row_ror:8 row_mask:0xf bank_mask:0xf
    v_add_f32_dpp v128, v128, v128 row_ror:8 row_mask:0xf bank_mask:0xf
    v_add_f32_dpp v129, v129, v129 row_ror:8 row_mask:0xf bank_mask:0xf
    v_add_f32_dpp v130, v130, v130 row_ror:8 row_mask:0xf bank_mask:0xf
    v_add_f32_dpp v131, v131, v131 row_ror:8 row_mask:0xf bank_mask:0xf
    s_lshl_b32 s53, s34, 7
    s_add_u32 s53, s53, 143360
    v_lshl_add_u32 v157, v2, 5, s53
    s_mov_b32 s54, 0x00010001
    s_mov_b32 s55, 0x00010001
    s_mov_b64 exec, s[54:55]
    ds_write_b128 v157, v[124:127]
    ds_write_b128 v157, v[128:131] offset:16
    s_mov_b64 exec, 1
    v_mov_b32 v156, 1
    s_waitcnt lgkmcnt(0)
    ds_add_u32 v164, v156 offset:32
    s_mov_b64 exec, -1
    s_setprio 3
    s_waitcnt vmcnt(0)
    s_mov_b64 exec, 1
    v_mov_b32 v156, 1
    s_waitcnt lgkmcnt(0)
    ds_add_u32 v164, v156 offset:44
    s_mov_b64 exec, -1
    s_cmp_lg_u32 s34, 1
    s_cbranch_scc1 L_tb_pub
    s_mov_b32 s49, 0
Lspin_197:
    ds_read_b32 v156, v164 offset:32
    s_waitcnt lgkmcnt(0)
    v_readfirstlane_b32 s50, v156
    s_nop 0
    s_cmp_eq_u32 s50, 4
    s_cbranch_scc1 Lspun_198
    s_sleep 1
    s_add_u32 s49, s49, 1
    s_cmp_lt_u32 s49, 4194304
    s_cbranch_scc1 Lspin_197
Lspun_198:
    v_lshlrev_b32 v157, 4, v1
    v_add_u32 v158, 143360, v157
    s_mov_b64 exec, 0xff
    ds_read_b128 v[124:127], v158 offset:0
    ds_read_b128 v[128:131], v158 offset:128
    ds_read_b128 v[132:135], v158 offset:256
    ds_read_b128 v[136:139], v158 offset:384
    s_waitcnt lgkmcnt(0)
    v_add_f32 v124, v124, v128
    v_add_f32 v132, v132, v136
    v_add_f32 v124, v124, v132
    v_add_f32 v125, v125, v129
    v_add_f32 v133, v133, v137
    v_add_f32 v125, v125, v133
    v_add_f32 v126, v126, v130
    v_add_f32 v134, v134, v138
    v_add_f32 v126, v126, v134
    v_add_f32 v127, v127, v131
    v_add_f32 v135, v135, v139
    v_add_f32 v127, v127, v135
    v_add_u32 v124, 0x200, v124
    v_and_b32 v124, 0xfffffc00, v124
    v_or_b32 v124, s90, v124
    v_add_u32 v125, 0x200, v125
    v_and_b32 v125, 0xfffffc00, v125
    v_or_b32 v125, s91, v125
    v_add_u32 v126, 0x200, v126
    v_and_b32 v126, 0xfffffc00, v126
    v_or_b32 v126, s92, v126
    v_add_u32 v127, 0x200, v127
    v_and_b32 v127, 0xfffffc00, v127
    v_or_b32 v127, s93, v127
    s_lshl_b32 s53, s2, 7
    s_add_u32 s53, s53, 137363456
    buffer_store_dwordx4 v[124:127], v157, s[12:15], s53 offen sc1
    s_mov_b64 exec, -1
L_tb_pub:
    s_mov_b32 s49, 0
Lspin_199:
    ds_read_b32 v156, v164 offset:44
    s_waitcnt lgkmcnt(0)
    v_readfirstlane_b32 s50, v156
    s_nop 0
    s_cmp_eq_u32 s50, 4
    s_cbranch_scc1 Lspun_200
    s_sleep 1
    s_add_u32 s49, s49, 1
    s_cmp_lt_u32 s49, 4194304
    s_cbranch_scc1 Lspin_199
Lspun_200:
    ds_read_u16 v24, v161 offset:0
    ds_read_u16 v25, v161 offset:128
    ds_read_u16 v26, v161 offset:256
    ds_read_u16 v27, v161 offset:384
    ds_read_u16 v28, v161 offset:512
    ds_read_u16 v29, v161 offset:640
    ds_read_u16 v30, v161 offset:768
    ds_read_u16 v31, v161 offset:896
    ds_read_u16 v32, v161 offset:4096
    ds_read_u16 v33, v161 offset:4224
    ds_read_u16 v34, v161 offset:4352
    ds_read_u16 v35, v161 offset:4480
    ds_read_u16 v36, v161 offset:4608
    ds_read_u16 v37, v161 offset:4736
    ds_read_u16 v38, v161 offset:4864
    ds_read_u16 v39, v161 offset:4992
    s_waitcnt lgkmcnt(8)
    v_lshl_or_b32 v4, v25, 16, v24
    v_lshl_or_b32 v5, v27, 16, v26
    v_lshl_or_b32 v6, v29, 16, v28
    v_lshl_or_b32 v7, v31, 16, v30
    ds_read_u16 v40, v161 offset:8192
    ds_read_u16 v41, v161 offset:8320
    ds_read_u16 v42, v161 offset:8448
    ds_read_u16 v43, v161 offset:8576
    ds_read_u16 v44, v161 offset:8704
    ds_read_u16 v45, v161 offset:8832
    ds_read_u16 v46, v161 offset:8960
    ds_read_u16 v47, v161 offset:9088
    s_waitcnt lgkmcnt(8)
    v_lshl_or_b32 v8, v33, 16, v32
    v_lshl_or_b32 v9, v35, 16, v34
    v_lshl_or_b32 v10, v37, 16, v36
    v_lshl_or_b32 v11, v39, 16, v38
    ds_read_u16 v48, v161 offset:12288
    ds_read_u16 v49, v161 offset:12416
    ds_read_u16 v50, v161 offset:12544
    ds_read_u16 v51, v161 offset:12672
    ds_read_u16 v52, v161 offset:12800
    ds_read_u16 v53, v161 offset:12928
    ds_read_u16 v54, v161 offset:13056
    ds_read_u16 v55, v161 offset:13184
    s_waitcnt lgkmcnt(8)
    v_lshl_or_b32 v12, v41, 16, v40
    v_lshl_or_b32 v13, v43, 16, v42
    v_lshl_or_b32 v14, v45, 16, v44
    v_lshl_or_b32 v15, v47, 16, v46
    s_waitcnt lgkmcnt(0)
    v_lshl_or_b32 v16, v49, 16, v48
    v_lshl_or_b32 v17, v51, 16, v50
    v_lshl_or_b32 v18, v53, 16, v52
    v_lshl_or_b32 v19, v55, 16, v54
    s_mov_b64 exec, 1
    v_mov_b32 v156, 1
    s_waitcnt lgkmcnt(0)
    ds_add_u32 v164, v156 offset:48
    s_mov_b64 exec, -1
L_tb_done:
L_svc_tail:
    s_cmp_lg_u32 s34, 1
    s_cbranch_scc1 L_noml
    s_mov_b32 s49, 0
Lspin_201:
    ds_read_b32 v100, v164 offset:8
    s_waitcnt lgkmcnt(0)
    v_readfirstlane_b32 s50, v100
    s_nop 0
    s_cmp_eq_u32 s50, 8
    s_cbranch_scc1 Lspun_202
    s_sleep 2
    s_add_u32 s49, s49, 1
    s_cmp_lt_u32 s49, 4194304
    s_cbranch_scc1 Lspin_201
Lspun_202:
    v_mov_b32 v101, 132224
    ds_read_b128 v[24:27], v101 offset:0
    ds_read_b128 v[28:31], v101 offset:16
    ds_read_b128 v[32:35], v101 offset:32
    ds_read_b128 v[36:39], v101 offset:48
    ds_read_b128 v[40:43], v101 offset:64
    ds_read_b128 v[44:47], v101 offset:80
    ds_read_b128 v[48:51], v101 offset:96
    ds_read_b128 v[52:55], v101 offset:112
    ds_read_b128 v[56:59], v101 offset:128
    ds_read_b128 v[60:63], v101 offset:144
    ds_read_b128 v[64:67], v101 offset:160
    ds_read_b128 v[68:71], v101 offset:176
    ds_read_b128 v[72:75], v101 offset:192
    ds_read_b128 v[76:79], v101 offset:208
    ds_read_b128 v[80:83], v101 offset:224
    ds_read_b128 v[84:87], v101 offset:240
    s_mov_b32 s53, 0x3fb8aa3b
    s_waitcnt lgkmcnt(8)
    v_max3_f32 v88, v24, v28, v32
    v_max3_f32 v89, v25, v29, v33
    v_max3_f32 v90, v26, v30, v34
    v_max3_f32 v91, v27, v31, v35
    v_max3_f32 v88, v88, v36, v40
    v_max3_f32 v89, v89, v37, v41
    v_max3_f32 v90, v90, v38, v42
    v_max3_f32 v91, v91, v39, v43
    v_max3_f32 v88, v88, v44, v48
    v_max3_f32 v89, v89, v45, v49
    v_max3_f32 v90, v90, v46, v50
    v_max3_f32 v91, v91, v47, v51
    v_max_f32 v88, v88, v52
    v_max_f32 v89, v89, v53
    v_max_f32 v90, v90, v54
    v_max_f32 v91, v91, v55
    v_mul_f32 v96, 0xbfb8aa3b, v88
    v_mul_f32 v97, 0xbfb8aa3b, v89
    v_mul_f32 v98, 0xbfb8aa3b, v90
    v_mul_f32 v99, 0xbfb8aa3b, v91
    v_fma_f32 v24, v24, s53, v96
    v_fma_f32 v25, v25, s53, v97
    v_fma_f32 v26, v26, s53, v98
    v_fma_f32 v27, v27, s53, v99
    v_fma_f32 v28, v28, s53, v96
    v_fma_f32 v29, v29, s53, v97
    v_fma_f32 v30, v30, s53, v98
    v_fma_f32 v31, v31, s53, v99
    v_fma_f32 v32, v32, s53, v96
    v_fma_f32 v33, v33, s53, v97
    v_fma_f32 v34, v34, s53, v98
    v_fma_f32 v35, v35, s53, v99
    v_fma_f32 v36, v36, s53, v96
    v_fma_f32 v37, v37, s53, v97
    v_fma_f32 v38, v38, s53, v98
    v_fma_f32 v39, v39, s53, v99
    v_fma_f32 v40, v40, s53, v96
    v_fma_f32 v41, v41, s53, v97
    v_fma_f32 v42, v42, s53, v98
    v_fma_f32 v43, v43, s53, v99
    v_fma_f32 v44, v44, s53, v96
    v_fma_f32 v45, v45, s53, v97
    v_fma_f32 v46, v46, s53, v98
    v_fma_f32 v47, v47, s53, v99
    v_fma_f32 v48, v48, s53, v96
    v_fma_f32 v49, v49, s53, v97
    v_fma_f32 v50, v50, s53, v98
    v_fma_f32 v51, v51, s53, v99
    v_fma_f32 v52, v52, s53, v96
    v_fma_f32 v53, v53, s53, v97
    v_fma_f32 v54, v54, s53, v98
    v_fma_f32 v55, v55, s53, v99
    v_exp_f32 v24, v24
    v_exp_f32 v25, v25
    v_exp_f32 v26, v26
    v_exp_f32 v27, v27
    v_exp_f32 v28, v28
    v_exp_f32 v29, v29
    v_exp_f32 v30, v30
    v_exp_f32 v31, v31
    v_exp_f32 v32, v32
    v_exp_f32 v33, v33
    v_exp_f32 v34, v34
    v_exp_f32 v35, v35
    v_exp_f32 v36, v36
    v_exp_f32 v37, v37
    v_exp_f32 v38, v38
    v_exp_f32 v39, v39
    v_exp_f32 v40, v40
    v_exp_f32 v41, v41
    v_exp_f32 v42, v42
    v_exp_f32 v43, v43
    v_exp_f32 v44, v44
    v_exp_f32 v45, v45
    v_exp_f32 v46, v46
    v_exp_f32 v47, v47
    v_exp_f32 v48, v48
    v_exp_f32 v49, v49
    v_exp_f32 v50, v50
    v_exp_f32 v51, v51
    v_exp_f32 v52, v52
    v_exp_f32 v53, v53
    v_exp_f32 v54, v54
    v_exp_f32 v55, v55
    s_waitcnt lgkmcnt(0)
    v_mul_f32 v92, v24, v56
    v_mul_f32 v93, v25, v57
    v_mul_f32 v94, v26, v58
    v_mul_f32 v95, v27, v59
    v_fmac_f32 v92, v28, v60
    v_fmac_f32 v93, v29, v61
    v_fmac_f32 v94, v30, v62
    v_fmac_f32 v95, v31, v63
    v_fmac_f32 v92, v32, v64
    v_fmac_f32 v93, v33, v65
    v_fmac_f32 v94, v34, v66
    v_fmac_f32 v95, v35, v67
    v_fmac_f32 v92, v36, v68
    v_fmac_f32 v93, v37, v69
    v_fmac_f32 v94, v38, v70
    v_fmac_f32 v95, v39, v71
    v_fmac_f32 v92, v40, v72
    v_fmac_f32 v93, v41, v73
    v_fmac_f32 v94, v42, v74
    v_fmac_f32 v95, v43, v75
    v_fmac_f32 v92, v44, v76
    v_fmac_f32 v93, v45, v77
    v_fmac_f32 v94, v46, v78
    v_fmac_f32 v95, v47, v79
    v_fmac_f32 v92, v48, v80
    v_fmac_f32 v93, v49, v81
    v_fmac_f32 v94, v50, v82
    v_fmac_f32 v95, v51, v83
    v_fmac_f32 v92, v52, v84
    v_fmac_f32 v93, v53, v85
    v_fmac_f32 v94, v54, v86
    v_fmac_f32 v95, v55, v87
    v_and_b32 v100, 1, v1
    v_cmp_eq_u32 vcc, 0, v100
    s_nop 1
    v_cndmask_b32 v92, v92, v88, vcc
    v_cndmask_b32 v93, v93, v89, vcc
    v_cndmask_b32 v94, v94, v90, vcc
    v_cndmask_b32 v95, v95, v91, vcc
    v_add_u32 v92, 0x200, v92
    v_and_b32 v92, 0xfffffc00, v92
    v_or_b32 v92, s90, v92
    v_add_u32 v93, 0x200, v93
    v_and_b32 v93, 0xfffffc00, v93
    v_or_b32 v93, s91, v93
    v_add_u32 v94, 0x200, v94
    v_and_b32 v94, 0xfffffc00, v94
    v_or_b32 v94, s92, v94
    v_add_u32 v95, 0x200, v95
    v_and_b32 v95, 0xfffffc00, v95
    v_or_b32 v95, s93, v95
    s_mov_b64 exec, 1
    ds_write_b128 v101, v[24:27] offset:384
    ds_write_b128 v101, v[28:31] offset:400
    ds_write_b128 v101, v[32:35] offset:416
    ds_write_b128 v101, v[36:39] offset:432
    ds_write_b128 v101, v[40:43] offset:448
    ds_write_b128 v101, v[44:47] offset:464
    ds_write_b128 v101, v[48:51] offset:480
    ds_write_b128 v101, v[52:55] offset:496
    s_mov_b64 exec, -1
    v_lshrrev_b32 v101, 1, v1
    v_lshlrev_b32 v101, 10, v101
    v_lshl_add_u32 v101, v100, 4, v101
    s_lshl_b32 s53, s44, 15
    s_lshl_b32 s54, s45, 7
    s_add_u32 s53, s53, s54
    s_lshl_b32 s54, s46, 5
    s_add_u32 s53, s53, s54
    s_add_u32 s53, s53, 136314880
    buffer_store_dwordx4 v[92:95], v101, s[12:15], s53 offen sc1
    s_mov_b64 exec, 1
    v_mov_b32 v100, 1
    s_waitcnt lgkmcnt(0)
    ds_add_u32 v164, v100 offset:20
    s_mov_b64 exec, -1
L_noml:
    s_mov_b32 s49, 0
Lspin_203:
    ds_read_b32 v20, v164 offset:12
    s_waitcnt lgkmcnt(0)
    v_readfirstlane_b32 s50, v20
    s_nop 0
    s_cmp_eq_u32 s50, 8
    s_cbranch_scc1 Lspun_204
    s_sleep 8
    s_add_u32 s49, s49, 1
    s_cmp_lt_u32 s49, 4194304
    s_cbranch_scc1 Lspin_203
Lspun_204:
    s_mov_b32 s49, 0
Lspin_205:
    ds_read_b32 v20, v164 offset:16
    s_waitcnt lgkmcnt(0)
    v_readfirstlane_b32 s50, v20
    s_nop 0
    s_cmp_eq_u32 s50, 4
    s_cbranch_scc1 Lspun_206
    s_sleep 1
    s_add_u32 s49, s49, 1
    s_cmp_lt_u32 s49, 4194304
    s_cbranch_scc1 Lspin_205
Lspun_206:
    v_and_b32 v20, 7, v3
    v_lshlrev_b32 v20, 8, v20
    v_lshl_add_u32 v20, v2, 4, v20
    v_add_u32 v20, 133120, v20
    ds_read_b128 v[24:27], v20 offset:0
    ds_read_b128 v[28:31], v20 offset:64
    ds_read_b128 v[32:35], v20 offset:128
    ds_read_b128 v[36:39], v20 offset:192
    s_waitcnt lgkmcnt(3)
    v_mfma_f32_16x16x32_bf16 v[40:43], v[4:7], v[24:27], 0
    s_waitcnt lgkmcnt(2)
    v_mfma_f32_16x16x32_bf16 v[40:43], v[8:11], v[28:31], v[40:43]
    s_waitcnt lgkmcnt(1)
    v_mfma_f32_16x16x32_bf16 v[40:43], v[12:15], v[32:35], v[40:43]
    s_waitcnt lgkmcnt(0)
    v_mfma_f32_16x16x32_bf16 v[40:43], v[16:19], v[36:39], v[40:43]
    v_lshlrev_b32 v21, 16, v3
    v_lshl_add_u32 v21, v2, 4, v21
    s_lshl_b32 s53, s94, 2
    s_add_u32 s53, s53, s95
    s_lshl_b32 s53, s53, 11
    s_lshl_b32 s54, s101, 8
    s_add_u32 s53, s53, s54
    s_lshl_b32 s54, s34, 6
    s_add_u32 s53, s53, s54
    s_add_u32 s53, s53, 135790592
    v_add_u32 v40, 0x200, v40
    v_and_b32 v40, 0xfffffc00, v40
    v_or_b32 v40, s90, v40
    v_add_u32 v41, 0x200, v41
    v_and_b32 v41, 0xfffffc00, v41
    v_or_b32 v41, s91, v41
    v_add_u32 v42, 0x200, v42
    v_and_b32 v42, 0xfffffc00, v42
    v_or_b32 v42, s92, v42
    v_add_u32 v43, 0x200, v43
    v_and_b32 v43, 0xfffffc00, v43
    v_or_b32 v43, s93, v43
    s_mov_b32 s56, 0x00ff00ff
    s_mov_b32 s57, 0x00ff00ff
    s_mov_b64 exec, s[56:57]
    buffer_store_dwordx4 v[40:43], v21, s[12:15], s53 offen sc1
    s_mov_b64 exec, -1
L_end:
    s_endpgm
.section .rodata,"a"
.p2align 6
.amdhsa_kernel sequential_preLN__gqa_block_cached__mixer_token_mlp__decode_kernel
  .amdhsa_next_free_vgpr 168
  .amdhsa_next_free_sgpr 102
  .amdhsa_accum_offset 168
  .amdhsa_group_segment_fixed_size 0
  .amdhsa_kernarg_size 104
  .amdhsa_user_sgpr_count 2
  .amdhsa_user_sgpr_kernarg_segment_ptr 1
  .amdhsa_system_sgpr_workgroup_id_x 1
.end_amdhsa_kernel
```
